```python
import torch

def _softmax(x, axis=-1):
    return torch.softmax(x, dim=axis)

def _gelu(x):
    return torch.nn.functional.gelu(x, approximate='tanh')

def _silu(x):
    return torch.nn.functional.silu(x)

def _sigmoid(x):
    return torch.sigmoid(x)

def _layernorm(x, axis=-1, eps=1e-05):
    m = x.mean(dim=axis, keepdim=True)
    v = x.var(dim=axis, keepdim=True, unbiased=False)
    return (x - m) / torch.sqrt(v + eps)

def _scatter_add(tgt, idx, src, axis=0):
    return tgt.clone().index_add_(axis, idx, src)

def _segment_sum(src, seg, n):
    out = torch.zeros((n,) + src.shape[1:], dtype=src.dtype)
    return out.index_add_(0, seg, src)

def _pad(x, pw):
    flat = tuple((v for pair in reversed(pw) for v in pair))
    return torch.nn.functional.pad(x, flat)
kernel_name = 'adaLN_cond__mha_block_cached__mixer_token_mlp__decode'

def setup_inputs():

    _w = lambda a: (lambda t: t.to(torch.bfloat16) if t.is_floating_point() else t)(torch.as_tensor(a))

    def _A_setup():
        B, Sq, D = (1, 1, 512)
        H, Sk, Dh = (32, 16384, 128)
        return {'x': _w((lambda *s: torch.randn(*s, dtype=torch.bfloat16) * 0.05)(B, Sq, D)), 'k_cache': _w((lambda *s: torch.randn(*s, dtype=torch.bfloat16) * 1.6)(B, H, Sk, Dh)), 'v_cache': _w((lambda *s: torch.randn(*s, dtype=torch.bfloat16) * 1.6)(B, H, Sk, Dh)), 'wq': _w((lambda *s: torch.randn(*s, dtype=torch.bfloat16) * 1.6)(D, H * Dh) * D ** (-0.5)), 'wo': _w((lambda *s: torch.randn(*s, dtype=torch.bfloat16) * 1.6)(H * Dh, D) * (H * Dh) ** (-0.5))}
    _A_in = _A_setup()

    def _B_setup():
        B, S, D, F = (1, 1, 512, 1376)
        return {'x': _w((lambda *s: torch.randn(*s, dtype=torch.bfloat16) * 0.05)(B, S, D)), 'w1': _w((lambda *s: torch.randn(*s, dtype=torch.bfloat16) * 1.6)(S, F) * S ** (-0.5)), 'b1': _w((lambda *s: torch.randn(*s, dtype=torch.bfloat16) * 1.6)(F) * 0.02), 'w2': _w((lambda *s: torch.randn(*s, dtype=torch.bfloat16) * 1.6)(F, S) * F ** (-0.5)), 'b2': _w((lambda *s: torch.randn(*s, dtype=torch.bfloat16) * 1.6)(S) * 0.02)}
    _B_in = _B_setup()
    return {'A_x': _A_in['x'], 'A_k_cache': _A_in['k_cache'], 'A_v_cache': _A_in['v_cache'], 'A_wq': _A_in['wq'], 'A_wo': _A_in['wo'], 'B_x': _B_in['x'], 'B_w1': _B_in['w1'], 'B_b1': _B_in['b1'], 'B_w2': _B_in['w2'], 'B_b2': _B_in['b2'], 'c': _w((lambda *s: torch.randn(*s, dtype=torch.bfloat16) * 0.05)(1, 512) * 8.0), 'w_mod': _w((lambda *s: torch.randn(*s, dtype=torch.bfloat16) * 0.05)(512, 6 * 512) * 512 ** (-0.5) * 8.0)}

def reference(A_x, A_k_cache, A_v_cache, A_wq, A_wo, B_x, B_w1, B_b1, B_w2, B_b2, c, w_mod):

    def _A_ref(x, k_cache, v_cache, wq, wo):
        B, Sq, D = x.shape
        H, Dh = (32, 128)
        q = (lambda x, *d: x.permute(*d))((x @ wq).reshape(B, Sq, H, Dh), 0, 2, 1, 3)
        scores = torch.einsum('bhqd,bhkd->bhqk', q, k_cache) * Dh ** (-0.5)
        p = _softmax(scores, axis=-1)
        o = torch.einsum('bhqk,bhkd->bhqd', p, v_cache)
        return (lambda x, *d: x.permute(*d))(o, 0, 2, 1, 3).reshape(B, Sq, H * Dh) @ wo

    def _B_ref(x, w1, b1, w2, b2):
        B, S, D = x.shape
        h = _layernorm(x, axis=-1)
        u = torch.einsum('bsd,sf->bdf', h, w1) + b1
        u = _gelu(u)
        y = torch.einsum('bdf,fs->bds', u, w2) + b2
        return (lambda x, *d: x.permute(*d))(y, 0, 2, 1)
    x = A_x
    mod = (_silu(c) @ w_mod).reshape(c.shape[0], 6, 1, -1)
    sa, ca, ga, sb, cb, gb = (mod[:, 0].clone(), mod[:, 1].clone(), mod[:, 2].clone(), mod[:, 3].clone(), mod[:, 4].clone(), mod[:, 5].clone())
    h = _layernorm(x, axis=-1) * (1 + ca) + sa
    x = x + ga * _A_ref(h, A_k_cache, A_v_cache, A_wq, A_wo)
    h = _layernorm(x, axis=-1) * (1 + cb) + sb
    x = x + gb * _B_ref(h, B_w1, B_b1, B_w2, B_b2)
    return x
```

```asm
; @launch grid=(256,1,1) block=(768,1,1) lds=163840
.amdgcn_target "amdgcn-amd-amdhsa--gfx950"
.text
.globl adaLN_cond__mha_block_cached__mixer_token_mlp__decode_kernel
.p2align 8
.type adaLN_cond__mha_block_cached__mixer_token_mlp__decode_kernel,@function
adaLN_cond__mha_block_cached__mixer_token_mlp__decode_kernel:
s_cmp_ge_u32 s2, 256
s_cbranch_scc1 L_done
s_load_dwordx16 s[8:23], s[0:1], 0
s_load_dwordx8 s[24:31], s[0:1], 64
s_load_dwordx4 s[32:35], s[0:1], 96
s_load_dwordx2 s[36:37], s[0:1], 112
v_lshrrev_b32 v1, 6, v0
v_and_b32 v2, 63, v0
v_readfirstlane_b32 s3, v1
s_sub_u32 s4, s2, 64
s_mul_i32 s5, s4, 171
s_lshr_b32 s5, s5, 10
s_mul_i32 s40, s5, 6
s_sub_u32 s4, s4, s40
s_cmp_lt_u32 s2, 64
s_cselect_b32 s4, 7, s4
s_mov_b32 s40, s2
s_cmp_lt_u32 s3, 4
s_cbranch_scc1 L_helper
s_sub_u32 s3, s3, 4
s_cmp_lt_u32 s4, 6
s_cbranch_scc1 L_stream
s_branch L_crole
L_helper:
v_mov_b32 v1, 0
v_mov_b32 v3, 1
ds_write_b32 v1, v1 offset:8256
ds_write_b32 v1, v1 offset:8260
ds_write_b32 v1, v1 offset:8264
ds_write_b32 v1, v1 offset:8268
s_waitcnt lgkmcnt(0)
s_load_dwordx2 s[52:53], s[36:37], 196608
s_barrier
s_waitcnt lgkmcnt(0)
s_add_u32 s52, s52, 1
s_addc_u32 s53, s53, 0
s_cmp_ge_u32 s4, 6
s_cbranch_scc1 L_h_mid
s_cmp_lg_u32 s3, 0
s_cbranch_scc1 L_h_qdone
s_setprio 3
v_and_b32 v4, 31, v2
s_lshl_b32 s46, s5, 9
s_add_u32 s46, s46, 131072
v_lshl_add_u32 v4, v4, 4, s46
global_load_dwordx4 v[100:103], v4, s[36:37] sc1
s_sleep 12
global_load_dwordx4 v[104:107], v4, s[36:37] sc1
s_sleep 12
global_load_dwordx4 v[108:111], v4, s[36:37] sc1
s_sleep 12
global_load_dwordx4 v[112:115], v4, s[36:37] sc1
s_sleep 12
s_mov_b32 s50, 0
L_qpoll:
s_waitcnt vmcnt(3)
v_cmp_ne_u64 vcc, s[52:53], v[102:103]
v_mov_b32 v24, v100
v_mov_b32 v25, v101
s_cmp_eq_u64 vcc, 0
s_cbranch_scc1 L_qgot
s_sleep 3
global_load_dwordx4 v[100:103], v4, s[36:37] sc1
s_waitcnt vmcnt(3)
v_cmp_ne_u64 vcc, s[52:53], v[106:107]
v_mov_b32 v24, v104
v_mov_b32 v25, v105
s_cmp_eq_u64 vcc, 0
s_cbranch_scc1 L_qgot
s_sleep 3
global_load_dwordx4 v[104:107], v4, s[36:37] sc1
s_waitcnt vmcnt(3)
v_cmp_ne_u64 vcc, s[52:53], v[110:111]
v_mov_b32 v24, v108
v_mov_b32 v25, v109
s_cmp_eq_u64 vcc, 0
s_cbranch_scc1 L_qgot
s_sleep 3
global_load_dwordx4 v[108:111], v4, s[36:37] sc1
s_waitcnt vmcnt(3)
v_cmp_ne_u64 vcc, s[52:53], v[114:115]
v_mov_b32 v24, v112
v_mov_b32 v25, v113
s_cmp_eq_u64 vcc, 0
s_cbranch_scc1 L_qgot
s_sleep 3
global_load_dwordx4 v[112:115], v4, s[36:37] sc1
s_add_u32 s50, s50, 1
s_cmp_lt_u32 s50, 0x20000
s_cbranch_scc1 L_qpoll
L_qgot:
v_and_b32 v4, 31, v2
v_lshlrev_b32 v4, 3, v4
ds_write_b64 v4, v[24:25] offset:8320
s_waitcnt lgkmcnt(0)
s_setprio 0
L_h_qdone:
s_barrier
s_branch L_lw1_in
L_lw1:
s_sleep 16
L_lw1_in:
ds_read_b32 v9, v1 offset:8260
s_waitcnt lgkmcnt(0)
v_readfirstlane_b32 s51, v9
s_nop 0
s_cmp_lt_u32 s51, 1
s_cbranch_scc1 L_lw1
s_branch L_h_mid2
L_h_mid:
s_branch L_lw2_in
L_lw2:
s_sleep 16
L_lw2_in:
ds_read_b32 v9, v1 offset:8260
s_waitcnt lgkmcnt(0)
v_readfirstlane_b32 s51, v9
s_nop 0
s_cmp_lt_u32 s51, 1
s_cbranch_scc1 L_lw2
s_sleep 100
L_h_mid2:
s_waitcnt vmcnt(0)
v_lshlrev_b32 v4, 1, v0
v_add_u32 v5, 1280, v0
v_min_u32 v5, 1375, v5
v_lshlrev_b32 v5, 1, v5
global_load_ushort v48, v4, s[20:21] offset:0
global_load_ushort v54, v4, s[22:23] offset:0
global_load_ushort v60, v4, s[24:25] offset:0
global_load_ushort v49, v4, s[20:21] offset:512
global_load_ushort v55, v4, s[22:23] offset:512
global_load_ushort v61, v4, s[24:25] offset:512
global_load_ushort v50, v4, s[20:21] offset:1024
global_load_ushort v56, v4, s[22:23] offset:1024
global_load_ushort v62, v4, s[24:25] offset:1024
global_load_ushort v51, v4, s[20:21] offset:1536
global_load_ushort v57, v4, s[22:23] offset:1536
global_load_ushort v63, v4, s[24:25] offset:1536
global_load_ushort v52, v4, s[20:21] offset:2048
global_load_ushort v58, v4, s[22:23] offset:2048
global_load_ushort v64, v4, s[24:25] offset:2048
global_load_ushort v53, v5, s[20:21]
global_load_ushort v59, v5, s[22:23]
global_load_ushort v65, v5, s[24:25]
global_load_ushort v66, v1, s[26:27]
v_lshlrev_b32 v4, 2, v0
global_load_dword v67, v4, s[8:9]
s_lshl_b32 s46, s3, 11
s_add_u32 s46, s46, 262144
s_and_b32 s47, s2, 7
s_lshl_b32 s47, s47, 13
s_add_u32 s46, s46, s47
v_lshl_add_u32 v4, v2, 4, s46
s_mov_b32 s50, 0
L_poll_m2:
global_load_dwordx4 v[100:103], v4, s[36:37] offset:0 sc1
global_load_dwordx4 v[104:107], v4, s[36:37] offset:1024 sc1
s_waitcnt vmcnt(0)
v_cmp_ne_u64 vcc, s[52:53], v[102:103]
v_cmp_ne_u64 s[54:55], s[52:53], v[106:107]
s_nop 0
s_or_b64 vcc, vcc, s[54:55]
s_cmp_eq_u64 vcc, 0
s_cbranch_scc1 L_poll_m2_done
s_sleep 64
s_add_u32 s50, s50, 1
s_cmp_lt_u32 s50, 0x40000
s_cbranch_scc1 L_poll_m2
L_poll_m2_done:
s_lshl_b32 s46, s3, 10
v_lshl_add_u32 v4, v2, 3, s46
ds_write_b64 v4, v[100:101] offset:0
ds_write_b64 v4, v[104:105] offset:512
s_waitcnt lgkmcnt(0)
s_mov_b64 exec, 1
ds_add_u32 v1, v3 offset:8256
s_mov_b64 exec, -1
s_branch L_lw3_in
L_lw3:
s_sleep 1
L_lw3_in:
ds_read_b32 v9, v1 offset:8256
s_waitcnt lgkmcnt(0)
v_readfirstlane_b32 s51, v9
s_nop 0
s_cmp_lt_u32 s51, 4
s_cbranch_scc1 L_lw3
v_lshlrev_b32 v4, 2, v0
ds_read_b32 v100, v4 offset:0
v_lshlrev_b32 v4, 4, v2
ds_read_b128 v[104:107], v4 offset:1024
ds_read_b128 v[108:111], v4 offset:2048
s_lshl_b32 s46, s2, 2
v_mov_b32 v4, s46
ds_read_b32 v101, v4 offset:1024
ds_read_b32 v102, v4 offset:2048
ds_read_b32 v103, v4 offset:3072
s_waitcnt lgkmcnt(0)
v_lshlrev_b32 v70, 16, v100
v_and_b32 v71, 0xffff0000, v100
v_lshlrev_b32 v72, 16, v104
v_and_b32 v73, 0xffff0000, v104
v_lshlrev_b32 v80, 16, v108
v_and_b32 v81, 0xffff0000, v108
v_lshlrev_b32 v74, 16, v105
v_and_b32 v75, 0xffff0000, v105
v_lshlrev_b32 v82, 16, v109
v_and_b32 v83, 0xffff0000, v109
v_lshlrev_b32 v76, 16, v106
v_and_b32 v77, 0xffff0000, v106
v_lshlrev_b32 v84, 16, v110
v_and_b32 v85, 0xffff0000, v110
v_lshlrev_b32 v78, 16, v107
v_and_b32 v79, 0xffff0000, v107
v_lshlrev_b32 v86, 16, v111
v_and_b32 v87, 0xffff0000, v111
v_lshlrev_b32 v88, 16, v101
v_and_b32 v89, 0xffff0000, v101
v_lshlrev_b32 v90, 16, v102
v_and_b32 v91, 0xffff0000, v102
v_lshlrev_b32 v92, 16, v103
v_and_b32 v93, 0xffff0000, v103
v_add_f32 v80, 1.0, v80
v_add_f32 v81, 1.0, v81
v_add_f32 v82, 1.0, v82
v_add_f32 v83, 1.0, v83
v_add_f32 v84, 1.0, v84
v_add_f32 v85, 1.0, v85
v_add_f32 v86, 1.0, v86
v_add_f32 v87, 1.0, v87
v_add_f32 v90, 1.0, v90
v_add_f32 v91, 1.0, v91
v_cvt_pk_bf16_f32 v4, v80, v81
v_lshlrev_b32 v80, 16, v4
v_and_b32 v81, 0xffff0000, v4
v_cvt_pk_bf16_f32 v4, v82, v83
v_lshlrev_b32 v82, 16, v4
v_and_b32 v83, 0xffff0000, v4
v_cvt_pk_bf16_f32 v4, v84, v85
v_lshlrev_b32 v84, 16, v4
v_and_b32 v85, 0xffff0000, v4
v_cvt_pk_bf16_f32 v4, v86, v87
v_lshlrev_b32 v86, 16, v4
v_and_b32 v87, 0xffff0000, v4
v_cvt_pk_bf16_f32 v4, v90, v91
v_lshlrev_b32 v90, 16, v4
v_and_b32 v91, 0xffff0000, v4
v_lshlrev_b32 v48, 16, v48
v_lshlrev_b32 v49, 16, v49
v_lshlrev_b32 v50, 16, v50
v_lshlrev_b32 v51, 16, v51
v_lshlrev_b32 v52, 16, v52
v_lshlrev_b32 v53, 16, v53
v_lshlrev_b32 v54, 16, v54
v_lshlrev_b32 v55, 16, v55
v_lshlrev_b32 v56, 16, v56
v_lshlrev_b32 v57, 16, v57
v_lshlrev_b32 v58, 16, v58
v_lshlrev_b32 v59, 16, v59
v_lshlrev_b32 v60, 16, v60
v_lshlrev_b32 v61, 16, v61
v_lshlrev_b32 v62, 16, v62
v_lshlrev_b32 v63, 16, v63
v_lshlrev_b32 v64, 16, v64
v_lshlrev_b32 v65, 16, v65
v_lshlrev_b32 v66, 16, v66
v_cmp_gt_u32 vcc, 96, v0
s_nop 1
v_cndmask_b32 v65, 0, v65, vcc
v_lshlrev_b32 v68, 16, v67
v_and_b32 v69, 0xffff0000, v67
v_mov_b32 v94, 0xc0135761
v_mov_b32 v95, 0xbdd2d3e8
v_mov_b32 v96, 1.0
s_and_b32 s47, s2, 7
s_lshl_b32 s47, s47, 15
s_add_u32 s47, s47, 1048576
v_lshl_add_u32 v16, v0, 4, s47
v_add_u32 v17, 4096, v16
v_add_u32 v18, 8192, v16
v_add_u32 v19, 12288, v16
v_add_u32 v20, 16384, v16
v_add_u32 v21, 20480, v16
v_add_u32 v22, 24576, v16
v_add_u32 v23, 28672, v16
v_and_b32 v10, 7, v2
v_lshlrev_b32 v10, 12, v10
s_lshl_b32 s46, s3, 10
s_add_u32 s47, s47, s46
v_add_u32 v10, s47, v10
v_lshlrev_b32 v15, 3, v0
v_lshlrev_b32 v97, 5, v2
s_lshl_b32 s46, s2, 3
v_mov_b32 v98, s46
s_lshl_b32 s46, s3, 3
v_mov_b32 v99, s46
s_branch L_lw4_in
L_lw4:
s_sleep 8
L_lw4_in:
ds_read_b32 v9, v1 offset:8264
s_waitcnt lgkmcnt(0)
v_readfirstlane_b32 s51, v9
s_nop 0
s_cmp_lt_u32 s51, 8
s_cbranch_scc1 L_lw4
s_setprio 3
s_mov_b32 s50, 0
L_gate:
global_load_dwordx4 v[112:115], v10, s[36:37] sc1
s_waitcnt vmcnt(0)
v_cmp_ne_u64 vcc, s[52:53], v[114:115]
s_nop 0
s_and_b32 s59, vcc_lo, 0xff
s_bcnt1_i32_b32 s59, s59
s_cmp_le_u32 s59, 4
s_cbranch_scc1 L_gate_done
s_sleep 4
s_add_u32 s50, s50, 1
s_cmp_lt_u32 s50, 0x40000
s_cbranch_scc1 L_gate
L_gate_done:
s_mov_b32 s50, 0
s_mov_b32 s58, 255
L_poll_h2:
s_bitcmp1_b32 s58, 7
s_cbranch_scc0 L_poll_h2_s0
global_load_dwordx4 v[112:115], v16, s[36:37] sc1
L_poll_h2_s0:
s_bitcmp1_b32 s58, 6
s_cbranch_scc0 L_poll_h2_s1
global_load_dwordx4 v[116:119], v17, s[36:37] sc1
L_poll_h2_s1:
s_bitcmp1_b32 s58, 5
s_cbranch_scc0 L_poll_h2_s2
global_load_dwordx4 v[120:123], v18, s[36:37] sc1
L_poll_h2_s2:
s_bitcmp1_b32 s58, 4
s_cbranch_scc0 L_poll_h2_s3
global_load_dwordx4 v[124:127], v19, s[36:37] sc1
L_poll_h2_s3:
s_bitcmp1_b32 s58, 3
s_cbranch_scc0 L_poll_h2_s4
global_load_dwordx4 v[128:131], v20, s[36:37] sc1
L_poll_h2_s4:
s_bitcmp1_b32 s58, 2
s_cbranch_scc0 L_poll_h2_s5
global_load_dwordx4 v[132:135], v21, s[36:37] sc1
L_poll_h2_s5:
s_bitcmp1_b32 s58, 1
s_cbranch_scc0 L_poll_h2_s6
global_load_dwordx4 v[136:139], v22, s[36:37] sc1
L_poll_h2_s6:
s_bitcmp1_b32 s58, 0
s_cbranch_scc0 L_poll_h2_s7
global_load_dwordx4 v[140:143], v23, s[36:37] sc1
L_poll_h2_s7:
s_waitcnt vmcnt(0)
s_mov_b32 s58, 0
v_cmp_ne_u64 s[54:55], s[52:53], v[114:115]
s_nop 0
s_cmp_lg_u64 s[54:55], 0
s_addc_u32 s58, s58, s58
v_cmp_ne_u64 s[56:57], s[52:53], v[118:119]
s_nop 0
s_cmp_lg_u64 s[56:57], 0
s_addc_u32 s58, s58, s58
v_cmp_ne_u64 s[54:55], s[52:53], v[122:123]
s_nop 0
s_cmp_lg_u64 s[54:55], 0
s_addc_u32 s58, s58, s58
v_cmp_ne_u64 s[56:57], s[52:53], v[126:127]
s_nop 0
s_cmp_lg_u64 s[56:57], 0
s_addc_u32 s58, s58, s58
v_cmp_ne_u64 s[54:55], s[52:53], v[130:131]
s_nop 0
s_cmp_lg_u64 s[54:55], 0
s_addc_u32 s58, s58, s58
v_cmp_ne_u64 s[56:57], s[52:53], v[134:135]
s_nop 0
s_cmp_lg_u64 s[56:57], 0
s_addc_u32 s58, s58, s58
v_cmp_ne_u64 s[54:55], s[52:53], v[138:139]
s_nop 0
s_cmp_lg_u64 s[54:55], 0
s_addc_u32 s58, s58, s58
v_cmp_ne_u64 s[56:57], s[52:53], v[142:143]
s_nop 0
s_cmp_lg_u64 s[56:57], 0
s_addc_u32 s58, s58, s58
s_cmp_eq_u32 s58, 0
s_cbranch_scc1 L_poll_h2_done
s_bcnt1_i32_b32 s59, s58
s_cmp_le_u32 s59, 8
s_cbranch_scc1 L_poll_h2_ns
s_sleep 2
L_poll_h2_ns:
s_add_u32 s50, s50, 1
s_cmp_lt_u32 s50, 0x40000
s_cbranch_scc1 L_poll_h2
L_poll_h2_done:
v_pk_add_f32 v[112:113], v[112:113], v[128:129] op_sel:[0,0] op_sel_hi:[1,1]
v_pk_add_f32 v[116:117], v[116:117], v[132:133] op_sel:[0,0] op_sel_hi:[1,1]
v_pk_add_f32 v[120:121], v[120:121], v[136:137] op_sel:[0,0] op_sel_hi:[1,1]
v_pk_add_f32 v[124:125], v[124:125], v[140:141] op_sel:[0,0] op_sel_hi:[1,1]
v_pk_add_f32 v[112:113], v[112:113], v[120:121] op_sel:[0,0] op_sel_hi:[1,1]
v_pk_add_f32 v[116:117], v[116:117], v[124:125] op_sel:[0,0] op_sel_hi:[1,1]
v_pk_add_f32 v[112:113], v[112:113], v[116:117] op_sel:[0,0] op_sel_hi:[1,1]
v_cvt_pk_bf16_f32 v8, v112, v113
v_lshlrev_b32 v112, 16, v8
v_and_b32 v113, 0xffff0000, v8
v_pk_mul_f32 v[112:113], v[112:113], v[70:71] op_sel:[0,0] op_sel_hi:[1,1]
v_cvt_pk_bf16_f32 v8, v112, v113
v_lshlrev_b32 v112, 16, v8
v_and_b32 v113, 0xffff0000, v8
v_pk_add_f32 v[112:113], v[112:113], v[68:69] op_sel:[0,0] op_sel_hi:[1,1]
v_cvt_pk_bf16_f32 v8, v112, v113
v_lshlrev_b32 v112, 16, v8
v_and_b32 v113, 0xffff0000, v8
ds_write_b64 v15, v[112:113] offset:8704
s_waitcnt lgkmcnt(0)
s_barrier
ds_read_b128 v[112:115], v97 offset:8704
ds_read_b128 v[116:119], v97 offset:8720
ds_read_b64 v[144:145], v98 offset:8704
s_waitcnt lgkmcnt(1)
v_readfirstlane_b32 s46, v112
s_nop 1
v_pk_add_f32 v[120:121], v[112:113], s[46:47] op_sel:[0,0] op_sel_hi:[1,0] neg_lo:[0,1] neg_hi:[0,1]
v_pk_add_f32 v[122:123], v[114:115], s[46:47] op_sel:[0,0] op_sel_hi:[1,0] neg_lo:[0,1] neg_hi:[0,1]
v_pk_add_f32 v[124:125], v[116:117], s[46:47] op_sel:[0,0] op_sel_hi:[1,0] neg_lo:[0,1] neg_hi:[0,1]
v_pk_add_f32 v[126:127], v[118:119], s[46:47] op_sel:[0,0] op_sel_hi:[1,0] neg_lo:[0,1] neg_hi:[0,1]
v_pk_mul_f32 v[26:27], v[120:121], v[120:121] op_sel:[0,0] op_sel_hi:[1,1]
v_pk_add_f32 v[24:25], v[120:121], v[122:123] op_sel:[0,0] op_sel_hi:[1,1]
v_pk_fma_f32 v[26:27], v[122:123], v[122:123], v[26:27] op_sel:[0,0,0] op_sel_hi:[1,1,1]
v_pk_add_f32 v[28:29], v[124:125], v[126:127] op_sel:[0,0] op_sel_hi:[1,1]
v_pk_fma_f32 v[26:27], v[124:125], v[124:125], v[26:27] op_sel:[0,0,0] op_sel_hi:[1,1,1]
v_pk_add_f32 v[24:25], v[24:25], v[28:29] op_sel:[0,0] op_sel_hi:[1,1]
v_pk_fma_f32 v[26:27], v[126:127], v[126:127], v[26:27] op_sel:[0,0,0] op_sel_hi:[1,1,1]
v_add_f32 v24, v24, v25
v_add_f32 v25, v26, v27
s_nop 0
v_add_f32_dpp v24, v24, v24 quad_perm:[1,0,3,2] row_mask:0xf bank_mask:0xf
v_add_f32_dpp v25, v25, v25 quad_perm:[1,0,3,2] row_mask:0xf bank_mask:0xf
s_nop 0
v_add_f32_dpp v24, v24, v24 quad_perm:[2,3,0,1] row_mask:0xf bank_mask:0xf
v_add_f32_dpp v25, v25, v25 quad_perm:[2,3,0,1] row_mask:0xf bank_mask:0xf
s_nop 0
v_add_f32_dpp v24, v24, v24 row_half_mirror row_mask:0xf bank_mask:0xf
v_add_f32_dpp v25, v25, v25 row_half_mirror row_mask:0xf bank_mask:0xf
s_nop 0
v_add_f32_dpp v24, v24, v24 row_mirror row_mask:0xf bank_mask:0xf
v_add_f32_dpp v25, v25, v25 row_mirror row_mask:0xf bank_mask:0xf
v_mov_b32 v26, v24
v_mov_b32 v27, v25
s_nop 0
v_permlane16_swap_b32 v24, v26
v_permlane16_swap_b32 v25, v27
v_add_f32 v24, v24, v26
v_add_f32 v25, v25, v27
v_mov_b32 v26, v24
v_mov_b32 v27, v25
s_nop 0
v_permlane32_swap_b32 v24, v26
v_permlane32_swap_b32 v25, v27
v_add_f32 v24, v24, v26
v_add_f32 v25, v25, v27
v_mul_f32 v24, 0x3b000000, v24
v_mul_f32 v25, 0x3b000000, v25
v_fma_f32 v25, -v24, v24, v25
v_add_f32 v24, s46, v24
v_max_f32 v25, 0, v25
v_cvt_pk_bf16_f32 v26, v24, v25
v_lshlrev_b32 v24, 16, v26
v_and_b32 v25, 0xffff0000, v26
v_add_f32 v25, 0x3727c5ac, v25
v_cvt_pk_bf16_f32 v25, v25, v25
v_lshlrev_b32 v25, 16, v25
v_sqrt_f32 v25, v25
s_nop 0
v_cvt_pk_bf16_f32 v25, v25, v25
v_lshlrev_b32 v25, 16, v25
v_rcp_f32 v26, v25
s_waitcnt lgkmcnt(0)
v_pk_add_f32 v[112:113], v[112:113], v[24:25] op_sel:[0,0] op_sel_hi:[1,0] neg_lo:[0,1] neg_hi:[0,1]
v_pk_add_f32 v[114:115], v[114:115], v[24:25] op_sel:[0,0] op_sel_hi:[1,0] neg_lo:[0,1] neg_hi:[0,1]
v_pk_add_f32 v[116:117], v[116:117], v[24:25] op_sel:[0,0] op_sel_hi:[1,0] neg_lo:[0,1] neg_hi:[0,1]
v_pk_add_f32 v[118:119], v[118:119], v[24:25] op_sel:[0,0] op_sel_hi:[1,0] neg_lo:[0,1] neg_hi:[0,1]
v_pk_add_f32 v[146:147], v[144:145], v[24:25] op_sel:[0,0] op_sel_hi:[1,0] neg_lo:[0,1] neg_hi:[0,1]
v_cvt_pk_bf16_f32 v148, v112, v113
v_lshlrev_b32 v112, 16, v148
v_and_b32 v113, 0xffff0000, v148
v_cvt_pk_bf16_f32 v149, v114, v115
v_lshlrev_b32 v114, 16, v149
v_and_b32 v115, 0xffff0000, v149
v_cvt_pk_bf16_f32 v150, v116, v117
v_lshlrev_b32 v116, 16, v150
v_and_b32 v117, 0xffff0000, v150
v_cvt_pk_bf16_f32 v151, v118, v119
v_lshlrev_b32 v118, 16, v151
v_and_b32 v119, 0xffff0000, v151
v_cvt_pk_bf16_f32 v152, v146, v147
v_lshlrev_b32 v146, 16, v152
v_and_b32 v147, 0xffff0000, v152
v_pk_mul_f32 v[112:113], v[112:113], v[26:27] op_sel:[0,0] op_sel_hi:[1,0]
v_pk_mul_f32 v[114:115], v[114:115], v[26:27] op_sel:[0,0] op_sel_hi:[1,0]
v_pk_mul_f32 v[116:117], v[116:117], v[26:27] op_sel:[0,0] op_sel_hi:[1,0]
v_pk_mul_f32 v[118:119], v[118:119], v[26:27] op_sel:[0,0] op_sel_hi:[1,0]
v_mul_f32 v6, v146, v26
v_fma_f32 v8, -v6, v25, v146
v_fma_f32 v6, v8, v26, v6
v_mul_f32 v7, v147, v26
v_fma_f32 v9, -v7, v25, v147
v_fma_f32 v7, v9, v26, v7
v_mov_b32 v146, v6
v_mov_b32 v147, v7
v_cvt_pk_bf16_f32 v148, v112, v113
v_lshlrev_b32 v112, 16, v148
v_and_b32 v113, 0xffff0000, v148
v_cvt_pk_bf16_f32 v149, v114, v115
v_lshlrev_b32 v114, 16, v149
v_and_b32 v115, 0xffff0000, v149
v_cvt_pk_bf16_f32 v150, v116, v117
v_lshlrev_b32 v116, 16, v150
v_and_b32 v117, 0xffff0000, v150
v_cvt_pk_bf16_f32 v151, v118, v119
v_lshlrev_b32 v118, 16, v151
v_and_b32 v119, 0xffff0000, v151
v_cvt_pk_bf16_f32 v152, v146, v147
v_lshlrev_b32 v146, 16, v152
v_and_b32 v147, 0xffff0000, v152
v_pk_mul_f32 v[112:113], v[112:113], v[80:81] op_sel:[0,0] op_sel_hi:[1,1]
v_pk_mul_f32 v[114:115], v[114:115], v[82:83] op_sel:[0,0] op_sel_hi:[1,1]
v_pk_mul_f32 v[116:117], v[116:117], v[84:85] op_sel:[0,0] op_sel_hi:[1,1]
v_pk_mul_f32 v[118:119], v[118:119], v[86:87] op_sel:[0,0] op_sel_hi:[1,1]
v_pk_mul_f32 v[146:147], v[146:147], v[90:91] op_sel:[0,0] op_sel_hi:[1,1]
v_cvt_pk_bf16_f32 v148, v112, v113
v_lshlrev_b32 v112, 16, v148
v_and_b32 v113, 0xffff0000, v148
v_cvt_pk_bf16_f32 v149, v114, v115
v_lshlrev_b32 v114, 16, v149
v_and_b32 v115, 0xffff0000, v149
v_cvt_pk_bf16_f32 v150, v116, v117
v_lshlrev_b32 v116, 16, v150
v_and_b32 v117, 0xffff0000, v150
v_cvt_pk_bf16_f32 v151, v118, v119
v_lshlrev_b32 v118, 16, v151
v_and_b32 v119, 0xffff0000, v151
v_cvt_pk_bf16_f32 v152, v146, v147
v_lshlrev_b32 v146, 16, v152
v_and_b32 v147, 0xffff0000, v152
v_pk_add_f32 v[112:113], v[112:113], v[72:73] op_sel:[0,0] op_sel_hi:[1,1]
v_pk_add_f32 v[114:115], v[114:115], v[74:75] op_sel:[0,0] op_sel_hi:[1,1]
v_pk_add_f32 v[116:117], v[116:117], v[76:77] op_sel:[0,0] op_sel_hi:[1,1]
v_pk_add_f32 v[118:119], v[118:119], v[78:79] op_sel:[0,0] op_sel_hi:[1,1]
v_pk_add_f32 v[146:147], v[146:147], v[88:89] op_sel:[0,0] op_sel_hi:[1,1]
v_cvt_pk_bf16_f32 v148, v112, v113
v_lshlrev_b32 v112, 16, v148
v_and_b32 v113, 0xffff0000, v148
v_cvt_pk_bf16_f32 v149, v114, v115
v_lshlrev_b32 v114, 16, v149
v_and_b32 v115, 0xffff0000, v149
v_cvt_pk_bf16_f32 v150, v116, v117
v_lshlrev_b32 v116, 16, v150
v_and_b32 v117, 0xffff0000, v150
v_cvt_pk_bf16_f32 v151, v118, v119
v_lshlrev_b32 v118, 16, v151
v_and_b32 v119, 0xffff0000, v151
v_cvt_pk_bf16_f32 v152, v146, v147
v_lshlrev_b32 v146, 16, v152
v_and_b32 v147, 0xffff0000, v152
v_readfirstlane_b32 s46, v112
s_nop 1
v_pk_add_f32 v[120:121], v[112:113], s[46:47] op_sel:[0,0] op_sel_hi:[1,0] neg_lo:[0,1] neg_hi:[0,1]
v_pk_add_f32 v[122:123], v[114:115], s[46:47] op_sel:[0,0] op_sel_hi:[1,0] neg_lo:[0,1] neg_hi:[0,1]
v_pk_add_f32 v[124:125], v[116:117], s[46:47] op_sel:[0,0] op_sel_hi:[1,0] neg_lo:[0,1] neg_hi:[0,1]
v_pk_add_f32 v[126:127], v[118:119], s[46:47] op_sel:[0,0] op_sel_hi:[1,0] neg_lo:[0,1] neg_hi:[0,1]
v_pk_mul_f32 v[26:27], v[120:121], v[120:121] op_sel:[0,0] op_sel_hi:[1,1]
v_pk_add_f32 v[24:25], v[120:121], v[122:123] op_sel:[0,0] op_sel_hi:[1,1]
v_pk_fma_f32 v[26:27], v[122:123], v[122:123], v[26:27] op_sel:[0,0,0] op_sel_hi:[1,1,1]
v_pk_add_f32 v[28:29], v[124:125], v[126:127] op_sel:[0,0] op_sel_hi:[1,1]
v_pk_fma_f32 v[26:27], v[124:125], v[124:125], v[26:27] op_sel:[0,0,0] op_sel_hi:[1,1,1]
v_pk_add_f32 v[24:25], v[24:25], v[28:29] op_sel:[0,0] op_sel_hi:[1,1]
v_pk_fma_f32 v[26:27], v[126:127], v[126:127], v[26:27] op_sel:[0,0,0] op_sel_hi:[1,1,1]
v_add_f32 v24, v24, v25
v_add_f32 v25, v26, v27
s_nop 0
v_add_f32_dpp v24, v24, v24 quad_perm:[1,0,3,2] row_mask:0xf bank_mask:0xf
v_add_f32_dpp v25, v25, v25 quad_perm:[1,0,3,2] row_mask:0xf bank_mask:0xf
s_nop 0
v_add_f32_dpp v24, v24, v24 quad_perm:[2,3,0,1] row_mask:0xf bank_mask:0xf
v_add_f32_dpp v25, v25, v25 quad_perm:[2,3,0,1] row_mask:0xf bank_mask:0xf
s_nop 0
v_add_f32_dpp v24, v24, v24 row_half_mirror row_mask:0xf bank_mask:0xf
v_add_f32_dpp v25, v25, v25 row_half_mirror row_mask:0xf bank_mask:0xf
s_nop 0
v_add_f32_dpp v24, v24, v24 row_mirror row_mask:0xf bank_mask:0xf
v_add_f32_dpp v25, v25, v25 row_mirror row_mask:0xf bank_mask:0xf
v_mov_b32 v26, v24
v_mov_b32 v27, v25
s_nop 0
v_permlane16_swap_b32 v24, v26
v_permlane16_swap_b32 v25, v27
v_add_f32 v24, v24, v26
v_add_f32 v25, v25, v27
v_mov_b32 v26, v24
v_mov_b32 v27, v25
s_nop 0
v_permlane32_swap_b32 v24, v26
v_permlane32_swap_b32 v25, v27
v_add_f32 v24, v24, v26
v_add_f32 v25, v25, v27
v_mul_f32 v24, 0x3b000000, v24
v_mul_f32 v25, 0x3b000000, v25
v_fma_f32 v25, -v24, v24, v25
v_add_f32 v24, s46, v24
v_max_f32 v25, 0, v25
v_cvt_pk_bf16_f32 v26, v24, v25
v_lshlrev_b32 v24, 16, v26
v_and_b32 v25, 0xffff0000, v26
v_add_f32 v25, 0x3727c5ac, v25
v_cvt_pk_bf16_f32 v25, v25, v25
v_lshlrev_b32 v25, 16, v25
v_sqrt_f32 v25, v25
s_nop 0
v_cvt_pk_bf16_f32 v25, v25, v25
v_lshlrev_b32 v25, 16, v25
v_rcp_f32 v26, v25
v_pk_add_f32 v[146:147], v[146:147], v[24:25] op_sel:[0,0] op_sel_hi:[1,0] neg_lo:[0,1] neg_hi:[0,1]
v_cvt_pk_bf16_f32 v8, v146, v147
v_lshlrev_b32 v146, 16, v8
v_and_b32 v147, 0xffff0000, v8
v_mul_f32 v6, v146, v26
v_fma_f32 v8, -v6, v25, v146
v_fma_f32 v6, v8, v26, v6
v_mul_f32 v7, v147, v26
v_fma_f32 v9, -v7, v25, v147
v_fma_f32 v7, v9, v26, v7
v_cvt_pk_bf16_f32 v8, v6, v7
v_lshlrev_b32 v6, 16, v8
v_and_b32 v7, 0xffff0000, v8
v_pk_mul_f32 v[112:113], v[6:7], v[48:49] op_sel:[0,0] op_sel_hi:[1,0]
v_pk_mul_f32 v[116:117], v[6:7], v[48:49] op_sel:[0,1] op_sel_hi:[1,1]
v_pk_mul_f32 v[120:121], v[6:7], v[50:51] op_sel:[0,0] op_sel_hi:[1,0]
v_pk_mul_f32 v[124:125], v[6:7], v[50:51] op_sel:[0,1] op_sel_hi:[1,1]
v_pk_mul_f32 v[128:129], v[6:7], v[52:53] op_sel:[0,0] op_sel_hi:[1,0]
v_pk_mul_f32 v[132:133], v[6:7], v[52:53] op_sel:[0,1] op_sel_hi:[1,1]
v_cvt_pk_bf16_f32 v114, v112, v113
v_lshlrev_b32 v112, 16, v114
v_and_b32 v113, 0xffff0000, v114
v_cvt_pk_bf16_f32 v118, v116, v117
v_lshlrev_b32 v116, 16, v118
v_and_b32 v117, 0xffff0000, v118
v_cvt_pk_bf16_f32 v122, v120, v121
v_lshlrev_b32 v120, 16, v122
v_and_b32 v121, 0xffff0000, v122
v_cvt_pk_bf16_f32 v126, v124, v125
v_lshlrev_b32 v124, 16, v126
v_and_b32 v125, 0xffff0000, v126
v_cvt_pk_bf16_f32 v130, v128, v129
v_lshlrev_b32 v128, 16, v130
v_and_b32 v129, 0xffff0000, v130
v_cvt_pk_bf16_f32 v134, v132, v133
v_lshlrev_b32 v132, 16, v134
v_and_b32 v133, 0xffff0000, v134
v_pk_add_f32 v[112:113], v[112:113], v[54:55] op_sel:[0,0] op_sel_hi:[1,0]
v_pk_add_f32 v[116:117], v[116:117], v[54:55] op_sel:[0,1] op_sel_hi:[1,1]
v_pk_add_f32 v[120:121], v[120:121], v[56:57] op_sel:[0,0] op_sel_hi:[1,0]
v_pk_add_f32 v[124:125], v[124:125], v[56:57] op_sel:[0,1] op_sel_hi:[1,1]
v_pk_add_f32 v[128:129], v[128:129], v[58:59] op_sel:[0,0] op_sel_hi:[1,0]
v_pk_add_f32 v[132:133], v[132:133], v[58:59] op_sel:[0,1] op_sel_hi:[1,1]
v_cvt_pk_bf16_f32 v114, v112, v113
v_lshlrev_b32 v112, 16, v114
v_and_b32 v113, 0xffff0000, v114
v_cvt_pk_bf16_f32 v118, v116, v117
v_lshlrev_b32 v116, 16, v118
v_and_b32 v117, 0xffff0000, v118
v_cvt_pk_bf16_f32 v122, v120, v121
v_lshlrev_b32 v120, 16, v122
v_and_b32 v121, 0xffff0000, v122
v_cvt_pk_bf16_f32 v126, v124, v125
v_lshlrev_b32 v124, 16, v126
v_and_b32 v125, 0xffff0000, v126
v_cvt_pk_bf16_f32 v130, v128, v129
v_lshlrev_b32 v128, 16, v130
v_and_b32 v129, 0xffff0000, v130
v_cvt_pk_bf16_f32 v134, v132, v133
v_lshlrev_b32 v132, 16, v134
v_and_b32 v133, 0xffff0000, v134
v_pk_mul_f32 v[114:115], v[112:113], v[112:113] op_sel:[0,0] op_sel_hi:[1,1]
v_pk_mul_f32 v[118:119], v[116:117], v[116:117] op_sel:[0,0] op_sel_hi:[1,1]
v_pk_mul_f32 v[122:123], v[120:121], v[120:121] op_sel:[0,0] op_sel_hi:[1,1]
v_pk_mul_f32 v[126:127], v[124:125], v[124:125] op_sel:[0,0] op_sel_hi:[1,1]
v_pk_mul_f32 v[130:131], v[128:129], v[128:129] op_sel:[0,0] op_sel_hi:[1,1]
v_pk_mul_f32 v[134:135], v[132:133], v[132:133] op_sel:[0,0] op_sel_hi:[1,1]
v_pk_fma_f32 v[114:115], v[114:115], v[94:95], v[94:95] op_sel:[0,1,0] op_sel_hi:[1,1,0]
v_pk_fma_f32 v[118:119], v[118:119], v[94:95], v[94:95] op_sel:[0,1,0] op_sel_hi:[1,1,0]
v_pk_fma_f32 v[122:123], v[122:123], v[94:95], v[94:95] op_sel:[0,1,0] op_sel_hi:[1,1,0]
v_pk_fma_f32 v[126:127], v[126:127], v[94:95], v[94:95] op_sel:[0,1,0] op_sel_hi:[1,1,0]
v_pk_fma_f32 v[130:131], v[130:131], v[94:95], v[94:95] op_sel:[0,1,0] op_sel_hi:[1,1,0]
v_pk_fma_f32 v[134:135], v[134:135], v[94:95], v[94:95] op_sel:[0,1,0] op_sel_hi:[1,1,0]
v_pk_mul_f32 v[114:115], v[114:115], v[112:113] op_sel:[0,0] op_sel_hi:[1,1]
v_pk_mul_f32 v[118:119], v[118:119], v[116:117] op_sel:[0,0] op_sel_hi:[1,1]
v_pk_mul_f32 v[122:123], v[122:123], v[120:121] op_sel:[0,0] op_sel_hi:[1,1]
v_pk_mul_f32 v[126:127], v[126:127], v[124:125] op_sel:[0,0] op_sel_hi:[1,1]
v_pk_mul_f32 v[130:131], v[130:131], v[128:129] op_sel:[0,0] op_sel_hi:[1,1]
v_pk_mul_f32 v[134:135], v[134:135], v[132:133] op_sel:[0,0] op_sel_hi:[1,1]
v_exp_f32 v114, v114
v_exp_f32 v115, v115
v_exp_f32 v118, v118
v_exp_f32 v119, v119
v_exp_f32 v122, v122
v_exp_f32 v123, v123
v_exp_f32 v126, v126
v_exp_f32 v127, v127
v_exp_f32 v130, v130
v_exp_f32 v131, v131
v_exp_f32 v134, v134
v_exp_f32 v135, v135
v_pk_add_f32 v[114:115], v[114:115], v[96:97] op_sel:[0,0] op_sel_hi:[1,0]
v_pk_add_f32 v[118:119], v[118:119], v[96:97] op_sel:[0,0] op_sel_hi:[1,0]
v_pk_add_f32 v[122:123], v[122:123], v[96:97] op_sel:[0,0] op_sel_hi:[1,0]
v_pk_add_f32 v[126:127], v[126:127], v[96:97] op_sel:[0,0] op_sel_hi:[1,0]
v_pk_add_f32 v[130:131], v[130:131], v[96:97] op_sel:[0,0] op_sel_hi:[1,0]
v_pk_add_f32 v[134:135], v[134:135], v[96:97] op_sel:[0,0] op_sel_hi:[1,0]
v_rcp_f32 v114, v114
v_rcp_f32 v115, v115
v_rcp_f32 v118, v118
v_rcp_f32 v119, v119
v_rcp_f32 v122, v122
v_rcp_f32 v123, v123
v_rcp_f32 v126, v126
v_rcp_f32 v127, v127
v_rcp_f32 v130, v130
v_rcp_f32 v131, v131
v_rcp_f32 v134, v134
v_rcp_f32 v135, v135
v_pk_mul_f32 v[112:113], v[112:113], v[114:115] op_sel:[0,0] op_sel_hi:[1,1]
v_pk_mul_f32 v[116:117], v[116:117], v[118:119] op_sel:[0,0] op_sel_hi:[1,1]
v_pk_mul_f32 v[120:121], v[120:121], v[122:123] op_sel:[0,0] op_sel_hi:[1,1]
v_pk_mul_f32 v[124:125], v[124:125], v[126:127] op_sel:[0,0] op_sel_hi:[1,1]
v_pk_mul_f32 v[128:129], v[128:129], v[130:131] op_sel:[0,0] op_sel_hi:[1,1]
v_pk_mul_f32 v[132:133], v[132:133], v[134:135] op_sel:[0,0] op_sel_hi:[1,1]
v_cvt_pk_bf16_f32 v114, v112, v113
v_lshlrev_b32 v112, 16, v114
v_and_b32 v113, 0xffff0000, v114
v_cvt_pk_bf16_f32 v118, v116, v117
v_lshlrev_b32 v116, 16, v118
v_and_b32 v117, 0xffff0000, v118
v_cvt_pk_bf16_f32 v122, v120, v121
v_lshlrev_b32 v120, 16, v122
v_and_b32 v121, 0xffff0000, v122
v_cvt_pk_bf16_f32 v126, v124, v125
v_lshlrev_b32 v124, 16, v126
v_and_b32 v125, 0xffff0000, v126
v_cvt_pk_bf16_f32 v130, v128, v129
v_lshlrev_b32 v128, 16, v130
v_and_b32 v129, 0xffff0000, v130
v_cvt_pk_bf16_f32 v134, v132, v133
v_lshlrev_b32 v132, 16, v134
v_and_b32 v133, 0xffff0000, v134
v_pk_mul_f32 v[24:25], v[112:113], v[60:61] op_sel:[0,0] op_sel_hi:[1,0]
v_pk_mul_f32 v[26:27], v[116:117], v[60:61] op_sel:[0,1] op_sel_hi:[1,1]
v_pk_fma_f32 v[24:25], v[120:121], v[62:63], v[24:25] op_sel:[0,0,0] op_sel_hi:[1,0,1]
v_pk_fma_f32 v[26:27], v[124:125], v[62:63], v[26:27] op_sel:[0,1,0] op_sel_hi:[1,1,1]
v_pk_fma_f32 v[24:25], v[128:129], v[64:65], v[24:25] op_sel:[0,0,0] op_sel_hi:[1,0,1]
v_pk_fma_f32 v[26:27], v[132:133], v[64:65], v[26:27] op_sel:[0,1,0] op_sel_hi:[1,1,1]
v_pk_add_f32 v[24:25], v[24:25], v[26:27] op_sel:[0,0] op_sel_hi:[1,1]
s_nop 1
v_add_f32_dpp v24, v24, v24 quad_perm:[1,0,3,2] row_mask:0xf bank_mask:0xf
v_add_f32_dpp v25, v25, v25 quad_perm:[1,0,3,2] row_mask:0xf bank_mask:0xf
s_nop 0
v_add_f32_dpp v24, v24, v24 quad_perm:[2,3,0,1] row_mask:0xf bank_mask:0xf
v_add_f32_dpp v25, v25, v25 quad_perm:[2,3,0,1] row_mask:0xf bank_mask:0xf
s_nop 0
v_add_f32_dpp v24, v24, v24 row_half_mirror row_mask:0xf bank_mask:0xf
v_add_f32_dpp v25, v25, v25 row_half_mirror row_mask:0xf bank_mask:0xf
s_nop 0
v_add_f32_dpp v24, v24, v24 row_mirror row_mask:0xf bank_mask:0xf
v_add_f32_dpp v25, v25, v25 row_mirror row_mask:0xf bank_mask:0xf
v_mov_b32 v26, v24
v_mov_b32 v27, v25
s_nop 0
v_permlane16_swap_b32 v24, v26
v_permlane16_swap_b32 v25, v27
v_add_f32 v24, v24, v26
v_add_f32 v25, v25, v27
v_mov_b32 v26, v24
v_mov_b32 v27, v25
s_nop 0
v_permlane32_swap_b32 v24, v26
v_permlane32_swap_b32 v25, v27
v_add_f32 v24, v24, v26
v_add_f32 v25, v25, v27
ds_write_b64 v99, v[24:25] offset:10752
s_waitcnt lgkmcnt(0)
s_barrier
s_cmp_lg_u32 s3, 0
s_cbranch_scc1 L_done
ds_read_b128 v[24:27], v1 offset:10752
ds_read_b128 v[28:31], v1 offset:10768
s_lshl_b32 s46, s2, 2
v_mov_b32 v4, s46
s_mov_b64 exec, 1
s_waitcnt lgkmcnt(0)
v_pk_add_f32 v[24:25], v[24:25], v[26:27] op_sel:[0,0] op_sel_hi:[1,1]
v_pk_add_f32 v[28:29], v[28:29], v[30:31] op_sel:[0,0] op_sel_hi:[1,1]
v_pk_add_f32 v[24:25], v[24:25], v[28:29] op_sel:[0,0] op_sel_hi:[1,1]
v_cvt_pk_bf16_f32 v8, v24, v25
v_lshlrev_b32 v24, 16, v8
v_and_b32 v25, 0xffff0000, v8
v_pk_add_f32 v[24:25], v[24:25], v[66:67] op_sel:[0,0] op_sel_hi:[1,0]
v_cvt_pk_bf16_f32 v8, v24, v25
v_lshlrev_b32 v24, 16, v8
v_and_b32 v25, 0xffff0000, v8
v_pk_mul_f32 v[24:25], v[24:25], v[92:93] op_sel:[0,0] op_sel_hi:[1,1]
v_cvt_pk_bf16_f32 v8, v24, v25
v_lshlrev_b32 v24, 16, v8
v_and_b32 v25, 0xffff0000, v8
v_pk_add_f32 v[24:25], v[24:25], v[144:145] op_sel:[0,0] op_sel_hi:[1,1]
v_cvt_pk_bf16_f32 v24, v24, v25
global_store_dword v4, v24, s[32:33]
L_h_epoch:
s_cmp_lg_u32 s2, 0
s_cbranch_scc1 L_h_noepoch
v_mov_b32 v4, 196608
v_mov_b32 v6, s52
v_mov_b32 v7, s53
global_store_dwordx2 v4, v[6:7], s[36:37]
L_h_noepoch:
s_branch L_done
L_crole:
s_setprio 3
v_mov_b32 v1, 0
v_mov_b32 v3, 1
v_and_b32 v4, 7, v2
v_lshlrev_b32 v4, 4, v4
v_lshrrev_b32 v5, 3, v2
s_and_b32 s46, s40, 3
s_lshl_b32 s46, s46, 7
s_lshl_b32 s47, s3, 4
s_add_u32 s46, s46, s47
v_add_u32 v6, s46, v5
s_movk_i32 s47, 6144
v_mul_lo_u32 v7, v6, s47
v_lshlrev_b32 v6, 1, v6
s_lshr_b32 s46, s40, 2
s_lshl_b32 s46, s46, 7
v_add3_u32 v7, v7, v4, s46
s_lshl_b32 s46, s3, 6
v_lshl_add_u32 v8, v5, 3, s46
v_lshlrev_b32 v10, 13, v8
s_lshl_b32 s46, s40, 7
v_add3_u32 v10, v10, v4, s46
s_lshr_b32 s46, s40, 3
s_lshl_b32 s46, s46, 19
s_and_b32 s47, s40, 7
s_lshl_b32 s47, s47, 7
s_add_u32 s46, s46, s47
v_lshlrev_b32 v11, 10, v8
v_add3_u32 v11, v11, v4, s46
s_and_b32 s46, s40, 1
s_lshl_b32 s46, s46, 8
s_lshl_b32 s47, s3, 5
s_add_u32 s46, s46, s47
v_add_u32 v12, s46, v5
s_movk_i32 s47, 6144
v_mul_lo_u32 v13, v12, s47
v_lshlrev_b32 v12, 1, v12
s_lshr_b32 s46, s40, 1
s_add_u32 s46, s46, 16
s_lshl_b32 s46, s46, 7
v_add3_u32 v13, v13, v4, s46
v_lshlrev_b32 v14, 4, v2
s_lshl_b32 s46, s3, 8
s_and_b32 s46, s46, 0x3ff
v_lshl_add_u32 v15, v2, 2, s46
s_waitcnt lgkmcnt(0)
s_load_dwordx2 s[52:53], s[36:37], 196608
global_load_ushort v16, v6, s[28:29] offset:0
global_load_ushort v17, v6, s[28:29] offset:16
global_load_dwordx4 v[32:35], v7, s[30:31] nt
v_add_u32 v7, 49152, v7
global_load_dwordx4 v[36:39], v7, s[30:31] nt
global_load_dwordx4 v[120:123], v14, s[8:9]
global_load_dword v124, v15, s[8:9]
global_load_dwordx4 v[40:43], v10, s[14:15] nt
v_add_u32 v10, 8192, v10
global_load_dwordx4 v[44:47], v10, s[14:15] nt
v_add_u32 v10, 8192, v10
global_load_dwordx4 v[48:51], v10, s[14:15] nt
v_add_u32 v10, 8192, v10
global_load_dwordx4 v[52:55], v10, s[14:15] nt
v_add_u32 v10, 8192, v10
global_load_dwordx4 v[56:59], v10, s[14:15] nt
v_add_u32 v10, 8192, v10
global_load_dwordx4 v[60:63], v10, s[14:15] nt
v_add_u32 v10, 8192, v10
global_load_dwordx4 v[64:67], v10, s[14:15] nt
v_add_u32 v10, 8192, v10
global_load_dwordx4 v[68:71], v10, s[14:15] nt
s_barrier
v_and_b32 v6, 7, v2
v_lshlrev_b32 v6, 5, v6
v_lshrrev_b32 v7, 4, v2
v_lshl_add_u32 v6, v7, 3, v6
s_lshl_b32 s46, s3, 8
v_add_u32 v6, s46, v6
v_and_b32 v7, 31, v2
v_lshlrev_b32 v7, 3, v7
s_waitcnt vmcnt(12)
s_mov_b32 s46, 0xbfb8aa3b
v_lshlrev_b32 v16, 16, v16
v_lshlrev_b32 v17, 16, v17
v_mul_f32 v20, s46, v16
v_mul_f32 v21, s46, v17
v_exp_f32 v20, v20
v_exp_f32 v21, v21
v_add_f32 v20, 1.0, v20
v_add_f32 v21, 1.0, v21
v_rcp_f32 v22, v20
v_rcp_f32 v23, v21
v_mul_f32 v18, v16, v22
v_mul_f32 v19, v17, v23
v_fma_f32 v16, -v18, v20, v16
v_fma_f32 v17, -v19, v21, v17
v_fma_f32 v18, v16, v22, v18
v_fma_f32 v19, v17, v23, v19
v_cvt_pk_bf16_f32 v20, v18, v19
v_lshlrev_b32 v18, 16, v20
v_and_b32 v19, 0xffff0000, v20
s_waitcnt vmcnt(11)
v_lshlrev_b32 v20, 16, v32
v_and_b32 v21, 0xffff0000, v32
v_lshlrev_b32 v22, 16, v33
v_and_b32 v23, 0xffff0000, v33
v_lshlrev_b32 v24, 16, v34
v_and_b32 v25, 0xffff0000, v34
v_lshlrev_b32 v26, 16, v35
v_and_b32 v27, 0xffff0000, v35
v_pk_mul_f32 v[132:133], v[20:21], v[18:19] op_sel:[0,0] op_sel_hi:[1,0]
v_pk_mul_f32 v[134:135], v[22:23], v[18:19] op_sel:[0,0] op_sel_hi:[1,0]
v_pk_mul_f32 v[136:137], v[24:25], v[18:19] op_sel:[0,0] op_sel_hi:[1,0]
v_pk_mul_f32 v[138:139], v[26:27], v[18:19] op_sel:[0,0] op_sel_hi:[1,0]
s_waitcnt vmcnt(10)
v_lshlrev_b32 v20, 16, v36
v_and_b32 v21, 0xffff0000, v36
v_lshlrev_b32 v22, 16, v37
v_and_b32 v23, 0xffff0000, v37
v_lshlrev_b32 v24, 16, v38
v_and_b32 v25, 0xffff0000, v38
v_lshlrev_b32 v26, 16, v39
v_and_b32 v27, 0xffff0000, v39
v_pk_fma_f32 v[132:133], v[20:21], v[18:19], v[132:133] op_sel:[0,1,0] op_sel_hi:[1,1,1]
v_pk_fma_f32 v[134:135], v[22:23], v[18:19], v[134:135] op_sel:[0,1,0] op_sel_hi:[1,1,1]
v_pk_fma_f32 v[136:137], v[24:25], v[18:19], v[136:137] op_sel:[0,1,0] op_sel_hi:[1,1,1]
v_pk_fma_f32 v[138:139], v[26:27], v[18:19], v[138:139] op_sel:[0,1,0] op_sel_hi:[1,1,1]
s_nop 0
v_permlane32_swap_b32 v132, v136
v_permlane32_swap_b32 v133, v137
v_permlane32_swap_b32 v134, v138
v_permlane32_swap_b32 v135, v139
v_pk_add_f32 v[132:133], v[132:133], v[136:137] op_sel:[0,0] op_sel_hi:[1,1]
v_pk_add_f32 v[134:135], v[134:135], v[138:139] op_sel:[0,0] op_sel_hi:[1,1]
s_nop 1
v_permlane16_swap_b32 v132, v134
v_permlane16_swap_b32 v133, v135
v_pk_add_f32 v[132:133], v[132:133], v[134:135] op_sel:[0,0] op_sel_hi:[1,1]
s_nop 1
v_add_f32_dpp v132, v132, v132 row_ror:8 row_mask:0xf bank_mask:0xf
v_add_f32_dpp v133, v133, v133 row_ror:8 row_mask:0xf bank_mask:0xf
ds_write_b64 v6, v[132:133] offset:32768
s_waitcnt lgkmcnt(0)
s_mov_b64 exec, 1
ds_add_u32 v1, v3 offset:8268
s_mov_b64 exec, -1
L_lw5:
ds_read_b32 v9, v1 offset:8268
s_waitcnt lgkmcnt(0)
v_readfirstlane_b32 s51, v9
s_nop 0
s_cmp_lt_u32 s51, 8
s_cbranch_scc1 L_lw5
s_add_u32 s52, s52, 1
s_addc_u32 s53, s53, 0
s_cmp_lg_u32 s3, 0
s_cbranch_scc1 L_c_Adone
ds_read_b64 v[140:141], v7 offset:32768
ds_read_b64 v[142:143], v7 offset:33024
ds_read_b64 v[144:145], v7 offset:33280
ds_read_b64 v[146:147], v7 offset:33536
ds_read_b64 v[148:149], v7 offset:33792
ds_read_b64 v[150:151], v7 offset:34048
ds_read_b64 v[152:153], v7 offset:34304
ds_read_b64 v[154:155], v7 offset:34560
v_mov_b32 v26, s52
v_mov_b32 v27, s53
s_lshl_b32 s46, s40, 9
s_add_u32 s46, s46, 0
v_lshl_add_u32 v4, v7, 1, s46
v_lshrrev_b32 v5, 5, v2
v_lshl_add_u32 v4, v5, 15, v4
s_waitcnt lgkmcnt(0)
v_pk_add_f32 v[140:141], v[140:141], v[148:149] op_sel:[0,0] op_sel_hi:[1,1]
v_pk_add_f32 v[142:143], v[142:143], v[150:151] op_sel:[0,0] op_sel_hi:[1,1]
v_pk_add_f32 v[144:145], v[144:145], v[152:153] op_sel:[0,0] op_sel_hi:[1,1]
v_pk_add_f32 v[146:147], v[146:147], v[154:155] op_sel:[0,0] op_sel_hi:[1,1]
v_pk_add_f32 v[140:141], v[140:141], v[144:145] op_sel:[0,0] op_sel_hi:[1,1]
v_pk_add_f32 v[142:143], v[142:143], v[146:147] op_sel:[0,0] op_sel_hi:[1,1]
v_pk_add_f32 v[24:25], v[140:141], v[142:143] op_sel:[0,0] op_sel_hi:[1,1]
global_store_dwordx4 v4, v[24:27], s[36:37] sc1
L_c_Adone:
s_cmp_ge_u32 s3, 4
s_cbranch_scc1 L_c_hdone
s_waitcnt vmcnt(9)
s_cmp_eq_u32 s3, 0
s_cbranch_scc1 L_c_xok
s_waitcnt vmcnt(8)
L_c_xok:
v_lshlrev_b32 v140, 16, v120
v_and_b32 v141, 0xffff0000, v120
v_lshlrev_b32 v142, 16, v121
v_and_b32 v143, 0xffff0000, v121
v_lshlrev_b32 v144, 16, v122
v_and_b32 v145, 0xffff0000, v122
v_lshlrev_b32 v146, 16, v123
v_and_b32 v147, 0xffff0000, v123
v_readfirstlane_b32 s46, v140
s_nop 1
v_pk_add_f32 v[16:17], v[140:141], s[46:47] op_sel:[0,0] op_sel_hi:[1,0] neg_lo:[0,1] neg_hi:[0,1]
v_pk_add_f32 v[18:19], v[142:143], s[46:47] op_sel:[0,0] op_sel_hi:[1,0] neg_lo:[0,1] neg_hi:[0,1]
v_pk_add_f32 v[20:21], v[144:145], s[46:47] op_sel:[0,0] op_sel_hi:[1,0] neg_lo:[0,1] neg_hi:[0,1]
v_pk_add_f32 v[22:23], v[146:147], s[46:47] op_sel:[0,0] op_sel_hi:[1,0] neg_lo:[0,1] neg_hi:[0,1]
v_pk_mul_f32 v[150:151], v[16:17], v[16:17] op_sel:[0,0] op_sel_hi:[1,1]
v_pk_add_f32 v[148:149], v[16:17], v[18:19] op_sel:[0,0] op_sel_hi:[1,1]
v_pk_fma_f32 v[150:151], v[18:19], v[18:19], v[150:151] op_sel:[0,0,0] op_sel_hi:[1,1,1]
v_pk_add_f32 v[152:153], v[20:21], v[22:23] op_sel:[0,0] op_sel_hi:[1,1]
v_pk_fma_f32 v[150:151], v[20:21], v[20:21], v[150:151] op_sel:[0,0,0] op_sel_hi:[1,1,1]
v_pk_add_f32 v[148:149], v[148:149], v[152:153] op_sel:[0,0] op_sel_hi:[1,1]
v_pk_fma_f32 v[150:151], v[22:23], v[22:23], v[150:151] op_sel:[0,0,0] op_sel_hi:[1,1,1]
v_add_f32 v148, v148, v149
v_add_f32 v149, v150, v151
s_nop 0
v_add_f32_dpp v148, v148, v148 quad_perm:[1,0,3,2] row_mask:0xf bank_mask:0xf
v_add_f32_dpp v149, v149, v149 quad_perm:[1,0,3,2] row_mask:0xf bank_mask:0xf
s_nop 0
v_add_f32_dpp v148, v148, v148 quad_perm:[2,3,0,1] row_mask:0xf bank_mask:0xf
v_add_f32_dpp v149, v149, v149 quad_perm:[2,3,0,1] row_mask:0xf bank_mask:0xf
s_nop 0
v_add_f32_dpp v148, v148, v148 row_half_mirror row_mask:0xf bank_mask:0xf
v_add_f32_dpp v149, v149, v149 row_half_mirror row_mask:0xf bank_mask:0xf
s_nop 0
v_add_f32_dpp v148, v148, v148 row_mirror row_mask:0xf bank_mask:0xf
v_add_f32_dpp v149, v149, v149 row_mirror row_mask:0xf bank_mask:0xf
v_mov_b32 v150, v148
v_mov_b32 v151, v149
s_nop 0
v_permlane16_swap_b32 v148, v150
v_permlane16_swap_b32 v149, v151
v_add_f32 v148, v148, v150
v_add_f32 v149, v149, v151
v_mov_b32 v150, v148
v_mov_b32 v151, v149
s_nop 0
v_permlane32_swap_b32 v148, v150
v_permlane32_swap_b32 v149, v151
v_add_f32 v148, v148, v150
v_add_f32 v149, v149, v151
v_mul_f32 v148, 0x3b000000, v148
v_mul_f32 v149, 0x3b000000, v149
v_fma_f32 v149, -v148, v148, v149
v_add_f32 v148, s46, v148
v_max_f32 v149, 0, v149
v_cvt_pk_bf16_f32 v150, v148, v149
v_lshlrev_b32 v148, 16, v150
v_and_b32 v149, 0xffff0000, v150
v_add_f32 v149, 0x3727c5ac, v149
v_cvt_pk_bf16_f32 v149, v149, v149
v_lshlrev_b32 v149, 16, v149
v_sqrt_f32 v149, v149
s_nop 0
v_cvt_pk_bf16_f32 v149, v149, v149
v_lshlrev_b32 v149, 16, v149
v_rcp_f32 v150, v149
v_lshlrev_b32 v154, 16, v124
v_and_b32 v155, 0xffff0000, v124
v_pk_add_f32 v[154:155], v[154:155], v[148:149] op_sel:[0,0] op_sel_hi:[1,0] neg_lo:[0,1] neg_hi:[0,1]
v_cvt_pk_bf16_f32 v4, v154, v155
v_lshlrev_b32 v154, 16, v4
v_and_b32 v155, 0xffff0000, v4
v_mul_f32 v156, v154, v150
v_fma_f32 v4, -v156, v149, v154
v_fma_f32 v156, v4, v150, v156
v_mul_f32 v157, v155, v150
v_fma_f32 v5, -v157, v149, v155
v_fma_f32 v157, v5, v150, v157
v_cvt_pk_bf16_f32 v4, v156, v157
v_lshlrev_b32 v156, 16, v4
v_and_b32 v157, 0xffff0000, v4
v_lshrrev_b32 v4, 5, v2
v_lshlrev_b32 v4, 11, v4
v_lshl_add_u32 v4, v7, 1, v4
s_lshl_b32 s46, s3, 12
s_and_b32 s47, s40, 1
s_lshl_b32 s47, s47, 15
s_add_u32 s46, s46, s47
s_add_u32 s46, s46, 0
v_add_u32 v4, s46, v4
v_add_u32 v5, 16384, v4
v_mov_b32 v158, v156
v_mov_b32 v159, v157
s_mov_b32 s50, 0
s_mov_b32 s58, 255
L_poll_a:
s_bitcmp1_b32 s58, 7
s_cbranch_scc0 L_poll_a_s0
global_load_dwordx4 v[16:19], v4, s[36:37] offset:0 sc1
L_poll_a_s0:
s_bitcmp1_b32 s58, 6
s_cbranch_scc0 L_poll_a_s1
global_load_dwordx4 v[20:23], v4, s[36:37] offset:512 sc1
L_poll_a_s1:
s_bitcmp1_b32 s58, 5
s_cbranch_scc0 L_poll_a_s2
global_load_dwordx4 v[24:27], v4, s[36:37] offset:1024 sc1
L_poll_a_s2:
s_bitcmp1_b32 s58, 4
s_cbranch_scc0 L_poll_a_s3
global_load_dwordx4 v[28:31], v4, s[36:37] offset:1536 sc1
L_poll_a_s3:
s_bitcmp1_b32 s58, 3
s_cbranch_scc0 L_poll_a_s4
global_load_dwordx4 v[140:143], v5, s[36:37] offset:0 sc1
L_poll_a_s4:
s_bitcmp1_b32 s58, 2
s_cbranch_scc0 L_poll_a_s5
global_load_dwordx4 v[144:147], v5, s[36:37] offset:512 sc1
L_poll_a_s5:
s_bitcmp1_b32 s58, 1
s_cbranch_scc0 L_poll_a_s6
global_load_dwordx4 v[148:151], v5, s[36:37] offset:1024 sc1
L_poll_a_s6:
s_bitcmp1_b32 s58, 0
s_cbranch_scc0 L_poll_a_s7
global_load_dwordx4 v[152:155], v5, s[36:37] offset:1536 sc1
L_poll_a_s7:
s_waitcnt vmcnt(0)
s_mov_b32 s58, 0
v_cmp_ne_u64 s[54:55], s[52:53], v[18:19]
s_nop 0
s_cmp_lg_u64 s[54:55], 0
s_addc_u32 s58, s58, s58
v_cmp_ne_u64 s[56:57], s[52:53], v[22:23]
s_nop 0
s_cmp_lg_u64 s[56:57], 0
s_addc_u32 s58, s58, s58
v_cmp_ne_u64 s[54:55], s[52:53], v[26:27]
s_nop 0
s_cmp_lg_u64 s[54:55], 0
s_addc_u32 s58, s58, s58
v_cmp_ne_u64 s[56:57], s[52:53], v[30:31]
s_nop 0
s_cmp_lg_u64 s[56:57], 0
s_addc_u32 s58, s58, s58
v_cmp_ne_u64 s[54:55], s[52:53], v[142:143]
s_nop 0
s_cmp_lg_u64 s[54:55], 0
s_addc_u32 s58, s58, s58
v_cmp_ne_u64 s[56:57], s[52:53], v[146:147]
s_nop 0
s_cmp_lg_u64 s[56:57], 0
s_addc_u32 s58, s58, s58
v_cmp_ne_u64 s[54:55], s[52:53], v[150:151]
s_nop 0
s_cmp_lg_u64 s[54:55], 0
s_addc_u32 s58, s58, s58
v_cmp_ne_u64 s[56:57], s[52:53], v[154:155]
s_nop 0
s_cmp_lg_u64 s[56:57], 0
s_addc_u32 s58, s58, s58
s_cmp_eq_u32 s58, 0
s_cbranch_scc1 L_poll_a_done
s_bcnt1_i32_b32 s59, s58
s_cmp_le_u32 s59, 8
s_cbranch_scc1 L_poll_a_ns
s_sleep 2
L_poll_a_ns:
s_add_u32 s50, s50, 1
s_cmp_lt_u32 s50, 0x40000
s_cbranch_scc1 L_poll_a
L_poll_a_done:
v_pk_add_f32 v[16:17], v[16:17], v[20:21] op_sel:[0,0] op_sel_hi:[1,1]
v_pk_add_f32 v[24:25], v[24:25], v[28:29] op_sel:[0,0] op_sel_hi:[1,1]
v_pk_add_f32 v[140:141], v[140:141], v[144:145] op_sel:[0,0] op_sel_hi:[1,1]
v_pk_add_f32 v[148:149], v[148:149], v[152:153] op_sel:[0,0] op_sel_hi:[1,1]
v_pk_add_f32 v[16:17], v[16:17], v[24:25] op_sel:[0,0] op_sel_hi:[1,1]
v_pk_add_f32 v[140:141], v[140:141], v[148:149] op_sel:[0,0] op_sel_hi:[1,1]
v_cvt_pk_bf16_f32 v4, v16, v17
v_lshlrev_b32 v16, 16, v4
v_and_b32 v17, 0xffff0000, v4
v_cvt_pk_bf16_f32 v5, v140, v141
v_lshlrev_b32 v140, 16, v5
v_and_b32 v141, 0xffff0000, v5
v_add_f32 v140, 1.0, v140
v_add_f32 v141, 1.0, v141
v_cvt_pk_bf16_f32 v4, v140, v141
v_lshlrev_b32 v140, 16, v4
v_and_b32 v141, 0xffff0000, v4
v_pk_mul_f32 v[158:159], v[158:159], v[140:141] op_sel:[0,0] op_sel_hi:[1,1]
v_cvt_pk_bf16_f32 v4, v158, v159
v_lshlrev_b32 v158, 16, v4
v_and_b32 v159, 0xffff0000, v4
v_pk_add_f32 v[158:159], v[158:159], v[16:17] op_sel:[0,0] op_sel_hi:[1,1]
v_cvt_pk_bf16_f32 v4, v158, v159
v_lshlrev_b32 v158, 16, v4
v_and_b32 v159, 0xffff0000, v4
s_lshl_b32 s46, s3, 9
v_lshl_add_u32 v4, v2, 3, s46
ds_write_b64 v4, v[158:159] offset:40960
L_c_hdone:
s_waitcnt lgkmcnt(0)
s_mov_b64 exec, 1
ds_add_u32 v1, v3 offset:8268
s_mov_b64 exec, -1
L_lw6:
ds_read_b32 v9, v1 offset:8268
s_waitcnt lgkmcnt(0)
v_readfirstlane_b32 s51, v9
s_nop 0
s_cmp_lt_u32 s51, 16
s_cbranch_scc1 L_lw6
v_lshlrev_b32 v8, 2, v8
ds_read_b128 v[140:143], v8 offset:40960
ds_read_b128 v[144:147], v8 offset:40976
s_waitcnt vmcnt(0) lgkmcnt(0)
v_lshlrev_b32 v16, 16, v40
v_and_b32 v17, 0xffff0000, v40
v_lshlrev_b32 v18, 16, v41
v_and_b32 v19, 0xffff0000, v41
v_lshlrev_b32 v20, 16, v42
v_and_b32 v21, 0xffff0000, v42
v_lshlrev_b32 v22, 16, v43
v_and_b32 v23, 0xffff0000, v43
v_pk_mul_f32 v[132:133], v[16:17], v[140:141] op_sel:[0,0] op_sel_hi:[1,0]
v_pk_mul_f32 v[134:135], v[18:19], v[140:141] op_sel:[0,0] op_sel_hi:[1,0]
v_pk_mul_f32 v[136:137], v[20:21], v[140:141] op_sel:[0,0] op_sel_hi:[1,0]
v_pk_mul_f32 v[138:139], v[22:23], v[140:141] op_sel:[0,0] op_sel_hi:[1,0]
v_lshlrev_b32 v24, 16, v44
v_and_b32 v25, 0xffff0000, v44
v_lshlrev_b32 v26, 16, v45
v_and_b32 v27, 0xffff0000, v45
v_lshlrev_b32 v28, 16, v46
v_and_b32 v29, 0xffff0000, v46
v_lshlrev_b32 v30, 16, v47
v_and_b32 v31, 0xffff0000, v47
v_pk_fma_f32 v[132:133], v[24:25], v[140:141], v[132:133] op_sel:[0,1,0] op_sel_hi:[1,1,1]
v_pk_fma_f32 v[134:135], v[26:27], v[140:141], v[134:135] op_sel:[0,1,0] op_sel_hi:[1,1,1]
v_pk_fma_f32 v[136:137], v[28:29], v[140:141], v[136:137] op_sel:[0,1,0] op_sel_hi:[1,1,1]
v_pk_fma_f32 v[138:139], v[30:31], v[140:141], v[138:139] op_sel:[0,1,0] op_sel_hi:[1,1,1]
v_lshlrev_b32 v16, 16, v48
v_and_b32 v17, 0xffff0000, v48
v_lshlrev_b32 v18, 16, v49
v_and_b32 v19, 0xffff0000, v49
v_lshlrev_b32 v20, 16, v50
v_and_b32 v21, 0xffff0000, v50
v_lshlrev_b32 v22, 16, v51
v_and_b32 v23, 0xffff0000, v51
v_pk_fma_f32 v[132:133], v[16:17], v[142:143], v[132:133] op_sel:[0,0,0] op_sel_hi:[1,0,1]
v_pk_fma_f32 v[134:135], v[18:19], v[142:143], v[134:135] op_sel:[0,0,0] op_sel_hi:[1,0,1]
v_pk_fma_f32 v[136:137], v[20:21], v[142:143], v[136:137] op_sel:[0,0,0] op_sel_hi:[1,0,1]
v_pk_fma_f32 v[138:139], v[22:23], v[142:143], v[138:139] op_sel:[0,0,0] op_sel_hi:[1,0,1]
v_lshlrev_b32 v24, 16, v52
v_and_b32 v25, 0xffff0000, v52
v_lshlrev_b32 v26, 16, v53
v_and_b32 v27, 0xffff0000, v53
v_lshlrev_b32 v28, 16, v54
v_and_b32 v29, 0xffff0000, v54
v_lshlrev_b32 v30, 16, v55
v_and_b32 v31, 0xffff0000, v55
v_pk_fma_f32 v[132:133], v[24:25], v[142:143], v[132:133] op_sel:[0,1,0] op_sel_hi:[1,1,1]
v_pk_fma_f32 v[134:135], v[26:27], v[142:143], v[134:135] op_sel:[0,1,0] op_sel_hi:[1,1,1]
v_pk_fma_f32 v[136:137], v[28:29], v[142:143], v[136:137] op_sel:[0,1,0] op_sel_hi:[1,1,1]
v_pk_fma_f32 v[138:139], v[30:31], v[142:143], v[138:139] op_sel:[0,1,0] op_sel_hi:[1,1,1]
v_lshlrev_b32 v16, 16, v56
v_and_b32 v17, 0xffff0000, v56
v_lshlrev_b32 v18, 16, v57
v_and_b32 v19, 0xffff0000, v57
v_lshlrev_b32 v20, 16, v58
v_and_b32 v21, 0xffff0000, v58
v_lshlrev_b32 v22, 16, v59
v_and_b32 v23, 0xffff0000, v59
v_pk_fma_f32 v[132:133], v[16:17], v[144:145], v[132:133] op_sel:[0,0,0] op_sel_hi:[1,0,1]
v_pk_fma_f32 v[134:135], v[18:19], v[144:145], v[134:135] op_sel:[0,0,0] op_sel_hi:[1,0,1]
v_pk_fma_f32 v[136:137], v[20:21], v[144:145], v[136:137] op_sel:[0,0,0] op_sel_hi:[1,0,1]
v_pk_fma_f32 v[138:139], v[22:23], v[144:145], v[138:139] op_sel:[0,0,0] op_sel_hi:[1,0,1]
v_lshlrev_b32 v24, 16, v60
v_and_b32 v25, 0xffff0000, v60
v_lshlrev_b32 v26, 16, v61
v_and_b32 v27, 0xffff0000, v61
v_lshlrev_b32 v28, 16, v62
v_and_b32 v29, 0xffff0000, v62
v_lshlrev_b32 v30, 16, v63
v_and_b32 v31, 0xffff0000, v63
v_pk_fma_f32 v[132:133], v[24:25], v[144:145], v[132:133] op_sel:[0,1,0] op_sel_hi:[1,1,1]
v_pk_fma_f32 v[134:135], v[26:27], v[144:145], v[134:135] op_sel:[0,1,0] op_sel_hi:[1,1,1]
v_pk_fma_f32 v[136:137], v[28:29], v[144:145], v[136:137] op_sel:[0,1,0] op_sel_hi:[1,1,1]
v_pk_fma_f32 v[138:139], v[30:31], v[144:145], v[138:139] op_sel:[0,1,0] op_sel_hi:[1,1,1]
v_lshlrev_b32 v16, 16, v64
v_and_b32 v17, 0xffff0000, v64
v_lshlrev_b32 v18, 16, v65
v_and_b32 v19, 0xffff0000, v65
v_lshlrev_b32 v20, 16, v66
v_and_b32 v21, 0xffff0000, v66
v_lshlrev_b32 v22, 16, v67
v_and_b32 v23, 0xffff0000, v67
v_pk_fma_f32 v[132:133], v[16:17], v[146:147], v[132:133] op_sel:[0,0,0] op_sel_hi:[1,0,1]
v_pk_fma_f32 v[134:135], v[18:19], v[146:147], v[134:135] op_sel:[0,0,0] op_sel_hi:[1,0,1]
v_pk_fma_f32 v[136:137], v[20:21], v[146:147], v[136:137] op_sel:[0,0,0] op_sel_hi:[1,0,1]
v_pk_fma_f32 v[138:139], v[22:23], v[146:147], v[138:139] op_sel:[0,0,0] op_sel_hi:[1,0,1]
v_lshlrev_b32 v24, 16, v68
v_and_b32 v25, 0xffff0000, v68
v_lshlrev_b32 v26, 16, v69
v_and_b32 v27, 0xffff0000, v69
v_lshlrev_b32 v28, 16, v70
v_and_b32 v29, 0xffff0000, v70
v_lshlrev_b32 v30, 16, v71
v_and_b32 v31, 0xffff0000, v71
v_pk_fma_f32 v[132:133], v[24:25], v[146:147], v[132:133] op_sel:[0,1,0] op_sel_hi:[1,1,1]
v_pk_fma_f32 v[134:135], v[26:27], v[146:147], v[134:135] op_sel:[0,1,0] op_sel_hi:[1,1,1]
v_pk_fma_f32 v[136:137], v[28:29], v[146:147], v[136:137] op_sel:[0,1,0] op_sel_hi:[1,1,1]
v_pk_fma_f32 v[138:139], v[30:31], v[146:147], v[138:139] op_sel:[0,1,0] op_sel_hi:[1,1,1]
s_nop 0
v_permlane32_swap_b32 v132, v136
v_permlane32_swap_b32 v133, v137
v_permlane32_swap_b32 v134, v138
v_permlane32_swap_b32 v135, v139
v_pk_add_f32 v[132:133], v[132:133], v[136:137] op_sel:[0,0] op_sel_hi:[1,1]
v_pk_add_f32 v[134:135], v[134:135], v[138:139] op_sel:[0,0] op_sel_hi:[1,1]
s_nop 1
v_permlane16_swap_b32 v132, v134
v_permlane16_swap_b32 v133, v135
v_pk_add_f32 v[132:133], v[132:133], v[134:135] op_sel:[0,0] op_sel_hi:[1,1]
s_nop 1
v_add_f32_dpp v132, v132, v132 row_ror:8 row_mask:0xf bank_mask:0xf
v_add_f32_dpp v133, v133, v133 row_ror:8 row_mask:0xf bank_mask:0xf
ds_write_b64 v6, v[132:133] offset:36864
s_waitcnt lgkmcnt(0)
s_mov_b64 exec, 1
ds_add_u32 v1, v3 offset:8268
s_mov_b64 exec, -1
L_lw7:
ds_read_b32 v9, v1 offset:8268
s_waitcnt lgkmcnt(0)
v_readfirstlane_b32 s51, v9
s_nop 0
s_cmp_lt_u32 s51, 24
s_cbranch_scc1 L_lw7
s_cmp_lg_u32 s3, 0
s_cbranch_scc1 L_c_Bdone
ds_read_b64 v[140:141], v7 offset:36864
ds_read_b64 v[142:143], v7 offset:37120
ds_read_b64 v[144:145], v7 offset:37376
ds_read_b64 v[146:147], v7 offset:37632
ds_read_b64 v[148:149], v7 offset:37888
ds_read_b64 v[150:151], v7 offset:38144
ds_read_b64 v[152:153], v7 offset:38400
ds_read_b64 v[154:155], v7 offset:38656
v_mov_b32 v26, s52
v_mov_b32 v27, s53
s_lshl_b32 s46, s40, 8
s_add_u32 s46, s46, 131072
v_add_u32 v4, s46, v7
s_waitcnt lgkmcnt(0)
v_pk_add_f32 v[140:141], v[140:141], v[148:149] op_sel:[0,0] op_sel_hi:[1,1]
v_pk_add_f32 v[142:143], v[142:143], v[150:151] op_sel:[0,0] op_sel_hi:[1,1]
v_pk_add_f32 v[144:145], v[144:145], v[152:153] op_sel:[0,0] op_sel_hi:[1,1]
v_pk_add_f32 v[146:147], v[146:147], v[154:155] op_sel:[0,0] op_sel_hi:[1,1]
v_pk_add_f32 v[140:141], v[140:141], v[144:145] op_sel:[0,0] op_sel_hi:[1,1]
v_pk_add_f32 v[142:143], v[142:143], v[146:147] op_sel:[0,0] op_sel_hi:[1,1]
v_pk_add_f32 v[24:25], v[140:141], v[142:143] op_sel:[0,0] op_sel_hi:[1,1]
v_cvt_pk_bf16_f32 v24, v24, v25
s_nop 1
v_mov_b32_dpp v25, v24 quad_perm:[1,0,3,2] row_mask:0xf bank_mask:0xf
s_mov_b32 exec_lo, 0x55555555
s_mov_b32 exec_hi, 0
global_store_dwordx4 v4, v[24:27], s[36:37] sc1
s_mov_b64 exec, -1
L_c_Bdone:
s_setprio 0
global_load_ushort v126, v12, s[28:29] offset:0
global_load_ushort v127, v12, s[28:29] offset:16
global_load_ushort v128, v12, s[28:29] offset:32
global_load_ushort v129, v12, s[28:29] offset:48
global_load_dwordx4 v[72:75], v13, s[30:31] nt
v_add_u32 v13, 49152, v13
global_load_dwordx4 v[76:79], v13, s[30:31] nt
v_add_u32 v13, 49152, v13
global_load_dwordx4 v[80:83], v13, s[30:31] nt
v_add_u32 v13, 49152, v13
global_load_dwordx4 v[84:87], v13, s[30:31] nt
global_load_dwordx4 v[88:91], v11, s[16:17] offset:0 nt
global_load_dwordx4 v[92:95], v11, s[16:17] offset:1024 nt
global_load_dwordx4 v[96:99], v11, s[16:17] offset:2048 nt
global_load_dwordx4 v[100:103], v11, s[16:17] offset:3072 nt
v_add_u32 v11, 4096, v11
global_load_dwordx4 v[104:107], v11, s[16:17] offset:0 nt
global_load_dwordx4 v[108:111], v11, s[16:17] offset:1024 nt
global_load_dwordx4 v[112:115], v11, s[16:17] offset:2048 nt
global_load_dwordx4 v[116:119], v11, s[16:17] offset:3072 nt
s_waitcnt vmcnt(8)
s_mov_b32 s46, 0xbfb8aa3b
v_lshlrev_b32 v126, 16, v126
v_lshlrev_b32 v127, 16, v127
v_lshlrev_b32 v128, 16, v128
v_lshlrev_b32 v129, 16, v129
v_mul_f32 v16, s46, v126
v_mul_f32 v17, s46, v127
v_mul_f32 v18, s46, v128
v_mul_f32 v19, s46, v129
v_exp_f32 v16, v16
v_exp_f32 v17, v17
v_exp_f32 v18, v18
v_exp_f32 v19, v19
v_add_f32 v16, 1.0, v16
v_add_f32 v17, 1.0, v17
v_add_f32 v18, 1.0, v18
v_add_f32 v19, 1.0, v19
v_rcp_f32 v20, v16
v_rcp_f32 v21, v17
v_rcp_f32 v22, v18
v_rcp_f32 v23, v19
v_mul_f32 v140, v126, v20
v_mul_f32 v141, v127, v21
v_mul_f32 v142, v128, v22
v_mul_f32 v143, v129, v23
v_fma_f32 v126, -v140, v16, v126
v_fma_f32 v127, -v141, v17, v127
v_fma_f32 v128, -v142, v18, v128
v_fma_f32 v129, -v143, v19, v129
v_fma_f32 v140, v126, v20, v140
v_fma_f32 v141, v127, v21, v141
v_fma_f32 v142, v128, v22, v142
v_fma_f32 v143, v129, v23, v143
v_cvt_pk_bf16_f32 v16, v140, v141
v_lshlrev_b32 v140, 16, v16
v_and_b32 v141, 0xffff0000, v16
v_cvt_pk_bf16_f32 v16, v142, v143
v_lshlrev_b32 v142, 16, v16
v_and_b32 v143, 0xffff0000, v16
v_lshlrev_b32 v16, 16, v72
v_and_b32 v17, 0xffff0000, v72
v_lshlrev_b32 v18, 16, v73
v_and_b32 v19, 0xffff0000, v73
v_lshlrev_b32 v20, 16, v74
v_and_b32 v21, 0xffff0000, v74
v_lshlrev_b32 v22, 16, v75
v_and_b32 v23, 0xffff0000, v75
v_pk_mul_f32 v[132:133], v[16:17], v[140:141] op_sel:[0,0] op_sel_hi:[1,0]
v_pk_mul_f32 v[134:135], v[18:19], v[140:141] op_sel:[0,0] op_sel_hi:[1,0]
v_pk_mul_f32 v[136:137], v[20:21], v[140:141] op_sel:[0,0] op_sel_hi:[1,0]
v_pk_mul_f32 v[138:139], v[22:23], v[140:141] op_sel:[0,0] op_sel_hi:[1,0]
v_lshlrev_b32 v16, 16, v76
v_and_b32 v17, 0xffff0000, v76
v_lshlrev_b32 v18, 16, v77
v_and_b32 v19, 0xffff0000, v77
v_lshlrev_b32 v20, 16, v78
v_and_b32 v21, 0xffff0000, v78
v_lshlrev_b32 v22, 16, v79
v_and_b32 v23, 0xffff0000, v79
v_pk_fma_f32 v[132:133], v[16:17], v[140:141], v[132:133] op_sel:[0,1,0] op_sel_hi:[1,1,1]
v_pk_fma_f32 v[134:135], v[18:19], v[140:141], v[134:135] op_sel:[0,1,0] op_sel_hi:[1,1,1]
v_pk_fma_f32 v[136:137], v[20:21], v[140:141], v[136:137] op_sel:[0,1,0] op_sel_hi:[1,1,1]
v_pk_fma_f32 v[138:139], v[22:23], v[140:141], v[138:139] op_sel:[0,1,0] op_sel_hi:[1,1,1]
v_lshlrev_b32 v16, 16, v80
v_and_b32 v17, 0xffff0000, v80
v_lshlrev_b32 v18, 16, v81
v_and_b32 v19, 0xffff0000, v81
v_lshlrev_b32 v20, 16, v82
v_and_b32 v21, 0xffff0000, v82
v_lshlrev_b32 v22, 16, v83
v_and_b32 v23, 0xffff0000, v83
v_pk_fma_f32 v[132:133], v[16:17], v[142:143], v[132:133] op_sel:[0,0,0] op_sel_hi:[1,0,1]
v_pk_fma_f32 v[134:135], v[18:19], v[142:143], v[134:135] op_sel:[0,0,0] op_sel_hi:[1,0,1]
v_pk_fma_f32 v[136:137], v[20:21], v[142:143], v[136:137] op_sel:[0,0,0] op_sel_hi:[1,0,1]
v_pk_fma_f32 v[138:139], v[22:23], v[142:143], v[138:139] op_sel:[0,0,0] op_sel_hi:[1,0,1]
v_lshlrev_b32 v16, 16, v84
v_and_b32 v17, 0xffff0000, v84
v_lshlrev_b32 v18, 16, v85
v_and_b32 v19, 0xffff0000, v85
v_lshlrev_b32 v20, 16, v86
v_and_b32 v21, 0xffff0000, v86
v_lshlrev_b32 v22, 16, v87
v_and_b32 v23, 0xffff0000, v87
v_pk_fma_f32 v[132:133], v[16:17], v[142:143], v[132:133] op_sel:[0,1,0] op_sel_hi:[1,1,1]
v_pk_fma_f32 v[134:135], v[18:19], v[142:143], v[134:135] op_sel:[0,1,0] op_sel_hi:[1,1,1]
v_pk_fma_f32 v[136:137], v[20:21], v[142:143], v[136:137] op_sel:[0,1,0] op_sel_hi:[1,1,1]
v_pk_fma_f32 v[138:139], v[22:23], v[142:143], v[138:139] op_sel:[0,1,0] op_sel_hi:[1,1,1]
s_nop 0
v_permlane32_swap_b32 v132, v136
v_permlane32_swap_b32 v133, v137
v_permlane32_swap_b32 v134, v138
v_permlane32_swap_b32 v135, v139
v_pk_add_f32 v[132:133], v[132:133], v[136:137] op_sel:[0,0] op_sel_hi:[1,1]
v_pk_add_f32 v[134:135], v[134:135], v[138:139] op_sel:[0,0] op_sel_hi:[1,1]
s_nop 1
v_permlane16_swap_b32 v132, v134
v_permlane16_swap_b32 v133, v135
v_pk_add_f32 v[132:133], v[132:133], v[134:135] op_sel:[0,0] op_sel_hi:[1,1]
s_nop 1
v_add_f32_dpp v132, v132, v132 row_ror:8 row_mask:0xf bank_mask:0xf
v_add_f32_dpp v133, v133, v133 row_ror:8 row_mask:0xf bank_mask:0xf
ds_write_b64 v6, v[132:133] offset:32768
s_waitcnt lgkmcnt(0)
s_mov_b64 exec, 1
ds_add_u32 v1, v3 offset:8268
s_mov_b64 exec, -1
L_lw8:
ds_read_b32 v9, v1 offset:8268
s_waitcnt lgkmcnt(0)
v_readfirstlane_b32 s51, v9
s_nop 0
s_cmp_lt_u32 s51, 32
s_cbranch_scc1 L_lw8
s_cmp_lg_u32 s3, 4
s_cbranch_scc1 L_c_Mdone
ds_read_b64 v[140:141], v7 offset:32768
ds_read_b64 v[142:143], v7 offset:33024
ds_read_b64 v[144:145], v7 offset:33280
ds_read_b64 v[146:147], v7 offset:33536
ds_read_b64 v[148:149], v7 offset:33792
ds_read_b64 v[150:151], v7 offset:34048
ds_read_b64 v[152:153], v7 offset:34304
ds_read_b64 v[154:155], v7 offset:34560
v_mov_b32 v26, s52
v_mov_b32 v27, s53
s_lshl_b32 s46, s40, 9
s_add_u32 s46, s46, 65536
v_lshl_add_u32 v4, v7, 1, s46
s_waitcnt lgkmcnt(0)
v_pk_add_f32 v[140:141], v[140:141], v[148:149] op_sel:[0,0] op_sel_hi:[1,1]
v_pk_add_f32 v[142:143], v[142:143], v[150:151] op_sel:[0,0] op_sel_hi:[1,1]
v_pk_add_f32 v[144:145], v[144:145], v[152:153] op_sel:[0,0] op_sel_hi:[1,1]
v_pk_add_f32 v[146:147], v[146:147], v[154:155] op_sel:[0,0] op_sel_hi:[1,1]
v_pk_add_f32 v[140:141], v[140:141], v[144:145] op_sel:[0,0] op_sel_hi:[1,1]
v_pk_add_f32 v[142:143], v[142:143], v[146:147] op_sel:[0,0] op_sel_hi:[1,1]
v_pk_add_f32 v[24:25], v[140:141], v[142:143] op_sel:[0,0] op_sel_hi:[1,1]
s_mov_b32 exec_hi, 0
global_store_dwordx4 v4, v[24:27], s[36:37] sc1
s_mov_b64 exec, -1
v_and_b32 v4, 15, v2
v_lshlrev_b32 v4, 4, v4
v_bfe_u32 v5, v2, 4, 1
v_lshl_add_u32 v4, v5, 9, v4
s_lshr_b32 s46, s40, 1
s_lshl_b32 s46, s46, 10
s_and_b32 s47, s40, 1
s_lshl_b32 s47, s47, 8
s_add_u32 s46, s46, s47
s_add_u32 s46, s46, 65536
v_add_u32 v4, s46, v4
s_mov_b32 s50, 0
L_poll_r:
global_load_dwordx4 v[24:27], v4, s[36:37] sc1
s_waitcnt vmcnt(0)
v_cmp_ne_u64 vcc, s[52:53], v[26:27]
s_nop 0
s_cmp_eq_u64 vcc, 0
s_cbranch_scc1 L_poll_r_done
s_sleep 4
s_add_u32 s50, s50, 1
s_cmp_lt_u32 s50, 0x40000
s_cbranch_scc1 L_poll_r
L_poll_r_done:
v_mov_b32 v28, v24
v_mov_b32 v29, v25
s_nop 0
v_permlane16_swap_b32 v24, v28
v_permlane16_swap_b32 v25, v29
v_pk_add_f32 v[24:25], v[24:25], v[28:29] op_sel:[0,0] op_sel_hi:[1,1]
v_cvt_pk_bf16_f32 v24, v24, v25
s_nop 1
v_mov_b32_dpp v25, v24 quad_perm:[1,0,3,2] row_mask:0xf bank_mask:0xf
v_and_b32 v4, 15, v2
v_lshlrev_b32 v4, 3, v4
v_lshrrev_b32 v5, 4, v2
v_lshl_add_u32 v4, v5, 13, v4
s_lshl_b32 s46, s40, 7
s_add_u32 s46, s46, 262144
v_add_u32 v4, s46, v4
v_add_u32 v5, 0x8000, v4
s_mov_b32 s46, 0x55555555
s_mov_b32 s47, 0x55555555
s_mov_b64 exec, s[46:47]
global_store_dwordx4 v4, v[24:27], s[36:37] sc1
global_store_dwordx4 v5, v[24:27], s[36:37] sc1
s_mov_b64 exec, -1
ds_write_b32 v1, v3 offset:8260
L_c_Mdone:
s_waitcnt vmcnt(0)
v_mov_b32 v132, v88
v_mov_b32 v133, v89
v_mov_b32 v134, v90
v_mov_b32 v135, v91
v_mov_b32 v136, v92
v_mov_b32 v137, v93
v_mov_b32 v138, v94
v_mov_b32 v139, v95
v_mov_b32 v140, v96
v_mov_b32 v141, v97
v_mov_b32 v142, v98
v_mov_b32 v143, v99
v_mov_b32 v144, v100
v_mov_b32 v145, v101
v_mov_b32 v146, v102
v_mov_b32 v147, v103
v_mov_b32 v148, v104
v_mov_b32 v149, v105
v_mov_b32 v150, v106
v_mov_b32 v151, v107
v_mov_b32 v152, v108
v_mov_b32 v153, v109
v_mov_b32 v154, v110
v_mov_b32 v155, v111
v_mov_b32 v156, v112
v_mov_b32 v157, v113
v_mov_b32 v158, v114
v_mov_b32 v159, v115
v_mov_b32 v160, v116
v_mov_b32 v161, v117
v_mov_b32 v162, v118
v_mov_b32 v163, v119
v_lshlrev_b32 v32, 16, v132
v_and_b32 v33, 0xffff0000, v132
v_lshlrev_b32 v34, 16, v133
v_and_b32 v35, 0xffff0000, v133
v_lshlrev_b32 v36, 16, v134
v_and_b32 v37, 0xffff0000, v134
v_lshlrev_b32 v38, 16, v135
v_and_b32 v39, 0xffff0000, v135
v_lshlrev_b32 v40, 16, v136
v_and_b32 v41, 0xffff0000, v136
v_lshlrev_b32 v42, 16, v137
v_and_b32 v43, 0xffff0000, v137
v_lshlrev_b32 v44, 16, v138
v_and_b32 v45, 0xffff0000, v138
v_lshlrev_b32 v46, 16, v139
v_and_b32 v47, 0xffff0000, v139
v_lshlrev_b32 v48, 16, v140
v_and_b32 v49, 0xffff0000, v140
v_lshlrev_b32 v50, 16, v141
v_and_b32 v51, 0xffff0000, v141
v_lshlrev_b32 v52, 16, v142
v_and_b32 v53, 0xffff0000, v142
v_lshlrev_b32 v54, 16, v143
v_and_b32 v55, 0xffff0000, v143
v_lshlrev_b32 v56, 16, v144
v_and_b32 v57, 0xffff0000, v144
v_lshlrev_b32 v58, 16, v145
v_and_b32 v59, 0xffff0000, v145
v_lshlrev_b32 v60, 16, v146
v_and_b32 v61, 0xffff0000, v146
v_lshlrev_b32 v62, 16, v147
v_and_b32 v63, 0xffff0000, v147
v_lshlrev_b32 v64, 16, v148
v_and_b32 v65, 0xffff0000, v148
v_lshlrev_b32 v66, 16, v149
v_and_b32 v67, 0xffff0000, v149
v_lshlrev_b32 v68, 16, v150
v_and_b32 v69, 0xffff0000, v150
v_lshlrev_b32 v70, 16, v151
v_and_b32 v71, 0xffff0000, v151
v_lshlrev_b32 v72, 16, v152
v_and_b32 v73, 0xffff0000, v152
v_lshlrev_b32 v74, 16, v153
v_and_b32 v75, 0xffff0000, v153
v_lshlrev_b32 v76, 16, v154
v_and_b32 v77, 0xffff0000, v154
v_lshlrev_b32 v78, 16, v155
v_and_b32 v79, 0xffff0000, v155
v_lshlrev_b32 v80, 16, v156
v_and_b32 v81, 0xffff0000, v156
v_lshlrev_b32 v82, 16, v157
v_and_b32 v83, 0xffff0000, v157
v_lshlrev_b32 v84, 16, v158
v_and_b32 v85, 0xffff0000, v158
v_lshlrev_b32 v86, 16, v159
v_and_b32 v87, 0xffff0000, v159
v_lshlrev_b32 v88, 16, v160
v_and_b32 v89, 0xffff0000, v160
v_lshlrev_b32 v90, 16, v161
v_and_b32 v91, 0xffff0000, v161
v_lshlrev_b32 v92, 16, v162
v_and_b32 v93, 0xffff0000, v162
v_lshlrev_b32 v94, 16, v163
v_and_b32 v95, 0xffff0000, v163
s_mov_b32 s48, 0x3fb8aa3b
s_lshr_b32 s46, s40, 3
s_lshl_b32 s46, s46, 12
s_and_b32 s47, s40, 7
s_lshl_b32 s47, s47, 9
s_add_u32 s46, s46, s47
s_add_u32 s46, s46, 1048576
v_lshl_add_u32 v10, v7, 1, s46
v_lshrrev_b32 v5, 5, v2
v_lshl_add_u32 v10, v5, 15, v10
v_add_u32 v11, 65536, v10
v_add_u32 v12, 131072, v10
v_add_u32 v13, 196608, v10
s_cmp_ge_u32 s3, 4
s_cbranch_scc1 L_c_odone
s_lshr_b32 s46, s40, 3
s_lshl_b32 s46, s46, 2
s_add_u32 s46, s46, s3
s_lshl_b32 s47, s46, 7
s_add_u32 s47, s47, 163840
v_mov_b32 v5, s47
s_lshl_b32 s47, s46, 13
s_add_u32 s47, s47, 524288
v_lshl_add_u32 v4, v2, 4, s47
v_add_u32 v14, 4096, v4
s_lshl_b32 s46, s3, 9
v_lshl_add_u32 v15, v2, 3, s46
v_and_b32 v16, 7, v2
v_min_u32 v16, 5, v16
v_lshl_add_u32 v16, v16, 4, v5
s_mov_b32 s50, 0
L_gate1:
global_load_dwordx4 v[100:103], v16, s[36:37] sc1
s_waitcnt vmcnt(0)
v_cmp_ne_u64 vcc, s[52:53], v[102:103]
s_nop 0
s_and_b32 s59, vcc_lo, 0x3f
s_bcnt1_i32_b32 s59, s59
s_cmp_le_u32 s59, 2
s_cbranch_scc1 L_gate1_done
s_sleep 16
s_add_u32 s50, s50, 1
s_cmp_lt_u32 s50, 0x40000
s_cbranch_scc1 L_gate1
L_gate1_done:
s_mov_b32 s50, 0
s_mov_b32 s58, 63
L_poll_h1:
s_bitcmp1_b32 s58, 5
s_cbranch_scc0 L_poll_h1_s0
global_load_dwordx4 v[100:103], v5, s[36:37] offset:0 sc1
global_load_dwordx4 v[124:127], v4, s[36:37] offset:0 sc1
L_poll_h1_s0:
s_bitcmp1_b32 s58, 4
s_cbranch_scc0 L_poll_h1_s1
global_load_dwordx4 v[104:107], v5, s[36:37] offset:16 sc1
global_load_dwordx4 v[128:131], v4, s[36:37] offset:1024 sc1
L_poll_h1_s1:
s_bitcmp1_b32 s58, 3
s_cbranch_scc0 L_poll_h1_s2
global_load_dwordx4 v[108:111], v5, s[36:37] offset:32 sc1
global_load_dwordx4 v[132:135], v4, s[36:37] offset:2048 sc1
L_poll_h1_s2:
s_bitcmp1_b32 s58, 2
s_cbranch_scc0 L_poll_h1_s3
global_load_dwordx4 v[112:115], v5, s[36:37] offset:48 sc1
global_load_dwordx4 v[136:139], v4, s[36:37] offset:3072 sc1
L_poll_h1_s3:
s_bitcmp1_b32 s58, 1
s_cbranch_scc0 L_poll_h1_s4
global_load_dwordx4 v[116:119], v5, s[36:37] offset:64 sc1
global_load_dwordx4 v[140:143], v14, s[36:37] offset:0 sc1
L_poll_h1_s4:
s_bitcmp1_b32 s58, 0
s_cbranch_scc0 L_poll_h1_s5
global_load_dwordx4 v[120:123], v5, s[36:37] offset:80 sc1
global_load_dwordx4 v[144:147], v14, s[36:37] offset:1024 sc1
L_poll_h1_s5:
s_waitcnt vmcnt(0)
s_mov_b32 s58, 0
v_cmp_ne_u64 s[54:55], s[52:53], v[102:103]
v_cmp_ne_u64 vcc, s[52:53], v[126:127]
s_nop 0
s_or_b64 s[54:55], s[54:55], vcc
s_cmp_lg_u64 s[54:55], 0
s_addc_u32 s58, s58, s58
v_cmp_ne_u64 s[56:57], s[52:53], v[106:107]
v_cmp_ne_u64 vcc, s[52:53], v[130:131]
s_nop 0
s_or_b64 s[56:57], s[56:57], vcc
s_cmp_lg_u64 s[56:57], 0
s_addc_u32 s58, s58, s58
v_cmp_ne_u64 s[54:55], s[52:53], v[110:111]
v_cmp_ne_u64 vcc, s[52:53], v[134:135]
s_nop 0
s_or_b64 s[54:55], s[54:55], vcc
s_cmp_lg_u64 s[54:55], 0
s_addc_u32 s58, s58, s58
v_cmp_ne_u64 s[56:57], s[52:53], v[114:115]
v_cmp_ne_u64 vcc, s[52:53], v[138:139]
s_nop 0
s_or_b64 s[56:57], s[56:57], vcc
s_cmp_lg_u64 s[56:57], 0
s_addc_u32 s58, s58, s58
v_cmp_ne_u64 s[54:55], s[52:53], v[118:119]
v_cmp_ne_u64 vcc, s[52:53], v[142:143]
s_nop 0
s_or_b64 s[54:55], s[54:55], vcc
s_cmp_lg_u64 s[54:55], 0
s_addc_u32 s58, s58, s58
v_cmp_ne_u64 s[56:57], s[52:53], v[122:123]
v_cmp_ne_u64 vcc, s[52:53], v[146:147]
s_nop 0
s_or_b64 s[56:57], s[56:57], vcc
s_cmp_lg_u64 s[56:57], 0
s_addc_u32 s58, s58, s58
s_cmp_eq_u32 s58, 0
s_cbranch_scc1 L_poll_h1_done
s_bcnt1_i32_b32 s59, s58
s_cmp_le_u32 s59, 2
s_cbranch_scc1 L_poll_h1_ns
s_sleep 32
L_poll_h1_ns:
s_add_u32 s50, s50, 1
s_cmp_lt_u32 s50, 0x40000
s_cbranch_scc1 L_poll_h1
L_poll_h1_done:
s_setprio 3
v_max3_f32 v26, v100, v104, v108
v_max3_f32 v27, v112, v116, v120
v_max_f32 v26, v26, v27
v_mul_f32 v28, s48, v26
v_fma_f32 v100, v100, s48, -v28
v_fma_f32 v104, v104, s48, -v28
v_fma_f32 v108, v108, s48, -v28
v_fma_f32 v112, v112, s48, -v28
v_fma_f32 v116, v116, s48, -v28
v_fma_f32 v120, v120, s48, -v28
v_exp_f32 v100, v100
v_exp_f32 v104, v104
v_exp_f32 v108, v108
v_exp_f32 v112, v112
v_exp_f32 v116, v116
v_exp_f32 v120, v120
v_mul_f32 v27, v100, v101
v_mul_f32 v29, v104, v105
v_pk_mul_f32 v[24:25], v[124:125], v[100:101] op_sel:[0,0] op_sel_hi:[1,0]
v_pk_mul_f32 v[30:31], v[128:129], v[104:105] op_sel:[0,0] op_sel_hi:[1,0]
v_fmac_f32 v27, v108, v109
v_pk_fma_f32 v[24:25], v[132:133], v[108:109], v[24:25] op_sel:[0,0,0] op_sel_hi:[1,0,1]
v_fmac_f32 v29, v112, v113
v_pk_fma_f32 v[30:31], v[136:137], v[112:113], v[30:31] op_sel:[0,0,0] op_sel_hi:[1,0,1]
v_fmac_f32 v27, v116, v117
v_pk_fma_f32 v[24:25], v[140:141], v[116:117], v[24:25] op_sel:[0,0,0] op_sel_hi:[1,0,1]
v_fmac_f32 v29, v120, v121
v_pk_fma_f32 v[30:31], v[144:145], v[120:121], v[30:31] op_sel:[0,0,0] op_sel_hi:[1,0,1]
v_add_f32 v27, v27, v29
v_pk_add_f32 v[24:25], v[24:25], v[30:31] op_sel:[0,0] op_sel_hi:[1,1]
v_rcp_f32 v28, v27
s_nop 0
v_mul_f32 v30, v24, v28
v_fma_f32 v26, -v30, v27, v24
v_fma_f32 v30, v26, v28, v30
v_mul_f32 v31, v25, v28
v_fma_f32 v29, -v31, v27, v25
v_fma_f32 v31, v29, v28, v31
v_cvt_pk_bf16_f32 v28, v30, v31
v_lshlrev_b32 v30, 16, v28
v_and_b32 v31, 0xffff0000, v28
ds_write_b64 v15, v[30:31] offset:45056
s_mov_b64 exec, 1
ds_add_u32 v1, v3 offset:8264
ds_add_u32 v1, v3 offset:8264
s_mov_b64 exec, -1
L_c_odone:
s_waitcnt lgkmcnt(0)
s_mov_b64 exec, 1
ds_add_u32 v1, v3 offset:8268
s_mov_b64 exec, -1
s_branch L_lw9_in
L_lw9:
s_sleep 1
L_lw9_in:
ds_read_b32 v9, v1 offset:8268
s_waitcnt lgkmcnt(0)
v_readfirstlane_b32 s51, v9
s_nop 0
s_cmp_lt_u32 s51, 40
s_cbranch_scc1 L_lw9
s_setprio 3
ds_read_b128 v[100:103], v8 offset:45056
ds_read_b128 v[104:107], v8 offset:45072
s_waitcnt lgkmcnt(1)
v_pk_mul_f32 v[132:133], v[32:33], v[100:101] op_sel:[0,0] op_sel_hi:[1,0]
v_pk_mul_f32 v[134:135], v[34:35], v[100:101] op_sel:[0,0] op_sel_hi:[1,0]
v_pk_mul_f32 v[136:137], v[36:37], v[100:101] op_sel:[0,0] op_sel_hi:[1,0]
v_pk_mul_f32 v[138:139], v[38:39], v[100:101] op_sel:[0,0] op_sel_hi:[1,0]
v_pk_fma_f32 v[132:133], v[40:41], v[100:101], v[132:133] op_sel:[0,1,0] op_sel_hi:[1,1,1]
v_pk_fma_f32 v[134:135], v[42:43], v[100:101], v[134:135] op_sel:[0,1,0] op_sel_hi:[1,1,1]
v_pk_fma_f32 v[136:137], v[44:45], v[100:101], v[136:137] op_sel:[0,1,0] op_sel_hi:[1,1,1]
v_pk_fma_f32 v[138:139], v[46:47], v[100:101], v[138:139] op_sel:[0,1,0] op_sel_hi:[1,1,1]
v_pk_fma_f32 v[132:133], v[48:49], v[102:103], v[132:133] op_sel:[0,0,0] op_sel_hi:[1,0,1]
v_pk_fma_f32 v[134:135], v[50:51], v[102:103], v[134:135] op_sel:[0,0,0] op_sel_hi:[1,0,1]
v_pk_fma_f32 v[136:137], v[52:53], v[102:103], v[136:137] op_sel:[0,0,0] op_sel_hi:[1,0,1]
v_pk_fma_f32 v[138:139], v[54:55], v[102:103], v[138:139] op_sel:[0,0,0] op_sel_hi:[1,0,1]
v_pk_fma_f32 v[132:133], v[56:57], v[102:103], v[132:133] op_sel:[0,1,0] op_sel_hi:[1,1,1]
v_pk_fma_f32 v[134:135], v[58:59], v[102:103], v[134:135] op_sel:[0,1,0] op_sel_hi:[1,1,1]
v_pk_fma_f32 v[136:137], v[60:61], v[102:103], v[136:137] op_sel:[0,1,0] op_sel_hi:[1,1,1]
v_pk_fma_f32 v[138:139], v[62:63], v[102:103], v[138:139] op_sel:[0,1,0] op_sel_hi:[1,1,1]
s_waitcnt lgkmcnt(0)
v_pk_fma_f32 v[132:133], v[64:65], v[104:105], v[132:133] op_sel:[0,0,0] op_sel_hi:[1,0,1]
v_pk_fma_f32 v[134:135], v[66:67], v[104:105], v[134:135] op_sel:[0,0,0] op_sel_hi:[1,0,1]
v_pk_fma_f32 v[136:137], v[68:69], v[104:105], v[136:137] op_sel:[0,0,0] op_sel_hi:[1,0,1]
v_pk_fma_f32 v[138:139], v[70:71], v[104:105], v[138:139] op_sel:[0,0,0] op_sel_hi:[1,0,1]
v_pk_fma_f32 v[132:133], v[72:73], v[104:105], v[132:133] op_sel:[0,1,0] op_sel_hi:[1,1,1]
v_pk_fma_f32 v[134:135], v[74:75], v[104:105], v[134:135] op_sel:[0,1,0] op_sel_hi:[1,1,1]
v_pk_fma_f32 v[136:137], v[76:77], v[104:105], v[136:137] op_sel:[0,1,0] op_sel_hi:[1,1,1]
v_pk_fma_f32 v[138:139], v[78:79], v[104:105], v[138:139] op_sel:[0,1,0] op_sel_hi:[1,1,1]
v_pk_fma_f32 v[132:133], v[80:81], v[106:107], v[132:133] op_sel:[0,0,0] op_sel_hi:[1,0,1]
v_pk_fma_f32 v[134:135], v[82:83], v[106:107], v[134:135] op_sel:[0,0,0] op_sel_hi:[1,0,1]
v_pk_fma_f32 v[136:137], v[84:85], v[106:107], v[136:137] op_sel:[0,0,0] op_sel_hi:[1,0,1]
v_pk_fma_f32 v[138:139], v[86:87], v[106:107], v[138:139] op_sel:[0,0,0] op_sel_hi:[1,0,1]
v_pk_fma_f32 v[132:133], v[88:89], v[106:107], v[132:133] op_sel:[0,1,0] op_sel_hi:[1,1,1]
v_pk_fma_f32 v[134:135], v[90:91], v[106:107], v[134:135] op_sel:[0,1,0] op_sel_hi:[1,1,1]
v_pk_fma_f32 v[136:137], v[92:93], v[106:107], v[136:137] op_sel:[0,1,0] op_sel_hi:[1,1,1]
v_pk_fma_f32 v[138:139], v[94:95], v[106:107], v[138:139] op_sel:[0,1,0] op_sel_hi:[1,1,1]
s_nop 0
v_permlane32_swap_b32 v132, v136
v_permlane32_swap_b32 v133, v137
v_permlane32_swap_b32 v134, v138
v_permlane32_swap_b32 v135, v139
v_pk_add_f32 v[132:133], v[132:133], v[136:137] op_sel:[0,0] op_sel_hi:[1,1]
v_pk_add_f32 v[134:135], v[134:135], v[138:139] op_sel:[0,0] op_sel_hi:[1,1]
s_nop 1
v_permlane16_swap_b32 v132, v134
v_permlane16_swap_b32 v133, v135
v_pk_add_f32 v[132:133], v[132:133], v[134:135] op_sel:[0,0] op_sel_hi:[1,1]
s_nop 1
v_add_f32_dpp v132, v132, v132 row_ror:8 row_mask:0xf bank_mask:0xf
v_add_f32_dpp v133, v133, v133 row_ror:8 row_mask:0xf bank_mask:0xf
ds_write_b64 v6, v[132:133] offset:36864
s_waitcnt lgkmcnt(0)
s_mov_b64 exec, 1
ds_add_u32 v1, v3 offset:8268
s_mov_b64 exec, -1
s_cmp_lg_u32 s3, 0
s_cbranch_scc1 L_done
L_lw10:
ds_read_b32 v9, v1 offset:8268
s_waitcnt lgkmcnt(0)
v_readfirstlane_b32 s51, v9
s_nop 0
s_cmp_lt_u32 s51, 48
s_cbranch_scc1 L_lw10
ds_read_b64 v[140:141], v7 offset:36864
ds_read_b64 v[142:143], v7 offset:37120
ds_read_b64 v[144:145], v7 offset:37376
ds_read_b64 v[146:147], v7 offset:37632
ds_read_b64 v[148:149], v7 offset:37888
ds_read_b64 v[150:151], v7 offset:38144
ds_read_b64 v[152:153], v7 offset:38400
ds_read_b64 v[154:155], v7 offset:38656
v_mov_b32 v26, s52
v_mov_b32 v27, s53
s_waitcnt lgkmcnt(0)
v_pk_add_f32 v[140:141], v[140:141], v[148:149] op_sel:[0,0] op_sel_hi:[1,1]
v_pk_add_f32 v[142:143], v[142:143], v[150:151] op_sel:[0,0] op_sel_hi:[1,1]
v_pk_add_f32 v[144:145], v[144:145], v[152:153] op_sel:[0,0] op_sel_hi:[1,1]
v_pk_add_f32 v[146:147], v[146:147], v[154:155] op_sel:[0,0] op_sel_hi:[1,1]
v_pk_add_f32 v[140:141], v[140:141], v[144:145] op_sel:[0,0] op_sel_hi:[1,1]
v_pk_add_f32 v[142:143], v[142:143], v[146:147] op_sel:[0,0] op_sel_hi:[1,1]
v_pk_add_f32 v[24:25], v[140:141], v[142:143] op_sel:[0,0] op_sel_hi:[1,1]
global_store_dwordx4 v10, v[24:27], s[36:37] sc1
global_store_dwordx4 v11, v[24:27], s[36:37] sc1
global_store_dwordx4 v12, v[24:27], s[36:37] sc1
global_store_dwordx4 v13, v[24:27], s[36:37] sc1
s_branch L_done
L_stream:
s_lshl_b32 s7, s3, 12
v_lshl_add_u32 v38, v2, 4, s7
v_add_u32 v1, 0x10000, v38
s_lshl_b32 s7, s5, 22
s_mul_i32 s38, s4, 700416
s_add_u32 s7, s7, s38
s_movk_i32 s39, 171
s_cmp_eq_u32 s4, 5
s_cselect_b32 s38, 169, s39
s_waitcnt lgkmcnt(0)
s_load_dwordx2 s[52:53], s[36:37], 196608
s_add_u32 s40, s10, s7
s_addc_u32 s41, s11, 0
s_lshl_b32 s42, s38, 12
s_mov_b32 s43, 0x20000
s_add_u32 s44, s12, s7
s_addc_u32 s45, s13, 0
s_lshl_b32 s46, s38, 12
s_mov_b32 s47, 0x20000
s_sub_u32 s38, s38, s3
s_add_u32 s38, s38, 7
s_lshr_b32 s38, s38, 3
s_add_u32 s38, s38, 3
s_lshl_b32 s50, s3, 14
s_add_u32 s50, s50, 32768
v_mov_b32 v39, 0x40000000
s_add_u32 m0, s50, 0
s_nop 0
buffer_load_dwordx4 v38, s[40:43], 0 offen offset:0 nt lds
buffer_load_dwordx4 v38, s[40:43], 0 offen offset:1024 nt lds
buffer_load_dwordx4 v38, s[40:43], 0 offen offset:2048 nt lds
buffer_load_dwordx4 v38, s[40:43], 0 offen offset:3072 nt lds
s_add_u32 m0, s50, 4096
s_nop 0
buffer_load_dwordx4 v38, s[44:47], 0 offen offset:0 nt lds
buffer_load_dwordx4 v38, s[44:47], 0 offen offset:1024 nt lds
buffer_load_dwordx4 v38, s[44:47], 0 offen offset:2048 nt lds
buffer_load_dwordx4 v38, s[44:47], 0 offen offset:3072 nt lds
v_add_u32 v38, 0x8000, v38
s_mov_b32 s48, 0x3fb8aa3b
s_mov_b32 s49, 0x3db504f3
v_and_b32 v3, 15, v2
v_lshlrev_b32 v3, 4, v3
v_lshl_add_u32 v19, v2, 4, s50
s_mov_b32 s6, 0
s_mov_b32 s39, 0
s_barrier
.p2align 6
L_sloop:
s_waitcnt vmcnt(28) lgkmcnt(0)
v_dot2_f32_bf16 v18, v40, v4, 0
v_dot2_f32_bf16 v20, v44, v4, 0
v_dot2_f32_bf16 v22, v48, v4, 0
v_dot2_f32_bf16 v24, v52, v4, 0
v_dot2_f32_bf16 v18, v41, v5, v18
v_dot2_f32_bf16 v20, v45, v5, v20
v_dot2_f32_bf16 v22, v49, v5, v22
v_dot2_f32_bf16 v24, v53, v5, v24
v_dot2_f32_bf16 v18, v42, v6, v18
v_dot2_f32_bf16 v20, v46, v6, v20
v_dot2_f32_bf16 v22, v50, v6, v22
v_dot2_f32_bf16 v24, v54, v6, v24
v_dot2_f32_bf16 v18, v43, v7, v18
v_dot2_f32_bf16 v20, v47, v7, v20
v_dot2_f32_bf16 v22, v51, v7, v22
v_dot2_f32_bf16 v24, v55, v7, v24
s_cmp_eq_u32 s6, 2
s_cbranch_scc1 L_lds00
buffer_load_dwordx4 v[40:43], v1, s[40:43], 0 offen offset:0 nt
buffer_load_dwordx4 v[44:47], v1, s[40:43], 0 offen offset:1024 nt
buffer_load_dwordx4 v[48:51], v1, s[40:43], 0 offen offset:2048 nt
buffer_load_dwordx4 v[52:55], v1, s[40:43], 0 offen offset:3072 nt
L_ldsdone00:
v_add_f32_dpp v18, v18, v18 quad_perm:[1,0,3,2] row_mask:0xf bank_mask:0xf
v_add_f32_dpp v20, v20, v20 quad_perm:[1,0,3,2] row_mask:0xf bank_mask:0xf
v_add_f32_dpp v22, v22, v22 quad_perm:[1,0,3,2] row_mask:0xf bank_mask:0xf
v_add_f32_dpp v24, v24, v24 quad_perm:[1,0,3,2] row_mask:0xf bank_mask:0xf
v_add_f32_dpp v18, v18, v18 quad_perm:[2,3,0,1] row_mask:0xf bank_mask:0xf
v_add_f32_dpp v20, v20, v20 quad_perm:[2,3,0,1] row_mask:0xf bank_mask:0xf
v_add_f32_dpp v22, v22, v22 quad_perm:[2,3,0,1] row_mask:0xf bank_mask:0xf
v_add_f32_dpp v24, v24, v24 quad_perm:[2,3,0,1] row_mask:0xf bank_mask:0xf
v_add_f32_dpp v18, v18, v18 row_half_mirror row_mask:0xf bank_mask:0xf
v_add_f32_dpp v20, v20, v20 row_half_mirror row_mask:0xf bank_mask:0xf
v_add_f32_dpp v22, v22, v22 row_half_mirror row_mask:0xf bank_mask:0xf
v_add_f32_dpp v24, v24, v24 row_half_mirror row_mask:0xf bank_mask:0xf
v_add_f32_dpp v18, v18, v18 row_mirror row_mask:0xf bank_mask:0xf
v_add_f32_dpp v20, v20, v20 row_mirror row_mask:0xf bank_mask:0xf
v_add_f32_dpp v22, v22, v22 row_mirror row_mask:0xf bank_mask:0xf
v_add_f32_dpp v24, v24, v24 row_mirror row_mask:0xf bank_mask:0xf
v_cvt_pk_bf16_f32 v26, v18, v20
v_cvt_pk_bf16_f32 v27, v22, v24
v_lshlrev_b32 v18, 16, v26
v_and_b32 v20, 0xffff0000, v26
v_lshlrev_b32 v22, 16, v27
v_and_b32 v24, 0xffff0000, v27
v_mul_f32 v18, s49, v18
v_mul_f32 v20, s49, v20
v_mul_f32 v22, s49, v22
v_mul_f32 v24, s49, v24
v_cvt_pk_bf16_f32 v26, v18, v20
v_cvt_pk_bf16_f32 v27, v22, v24
v_lshlrev_b32 v18, 16, v26
v_and_b32 v20, 0xffff0000, v26
v_lshlrev_b32 v22, 16, v27
v_and_b32 v24, 0xffff0000, v27
v_max3_f32 v26, v16, v18, v20
v_max3_f32 v26, v26, v22, v24
v_mul_f32 v27, s48, v26
v_fma_f32 v28, v16, s48, -v27
v_fma_f32 v18, v18, s48, -v27
v_fma_f32 v20, v20, s48, -v27
v_fma_f32 v22, v22, s48, -v27
v_fma_f32 v24, v24, s48, -v27
v_exp_f32 v28, v28
v_exp_f32 v18, v18
v_exp_f32 v20, v20
v_exp_f32 v22, v22
v_exp_f32 v24, v24
v_mov_b32 v16, v26
v_pk_mul_f32 v[8:9], v[8:9], v[28:29] op_sel:[0,0] op_sel_hi:[1,0]
v_pk_mul_f32 v[10:11], v[10:11], v[28:29] op_sel:[0,0] op_sel_hi:[1,0]
v_pk_mul_f32 v[12:13], v[12:13], v[28:29] op_sel:[0,0] op_sel_hi:[1,0]
v_pk_mul_f32 v[14:15], v[14:15], v[28:29] op_sel:[0,0] op_sel_hi:[1,0]
v_fma_f32 v17, v17, v28, v18
v_add_f32 v26, v20, v22
v_add_f32 v17, v17, v24
v_add_f32 v17, v17, v26
s_waitcnt vmcnt(28)
v_lshlrev_b32 v30, 16, v56
v_and_b32 v31, 0xffff0000, v56
v_lshlrev_b32 v32, 16, v57
v_and_b32 v33, 0xffff0000, v57
v_lshlrev_b32 v34, 16, v58
v_and_b32 v35, 0xffff0000, v58
v_lshlrev_b32 v36, 16, v59
v_and_b32 v37, 0xffff0000, v59
v_pk_fma_f32 v[8:9], v[30:31], v[18:19], v[8:9] op_sel:[0,0,0] op_sel_hi:[1,0,1]
v_pk_fma_f32 v[10:11], v[32:33], v[18:19], v[10:11] op_sel:[0,0,0] op_sel_hi:[1,0,1]
v_pk_fma_f32 v[12:13], v[34:35], v[18:19], v[12:13] op_sel:[0,0,0] op_sel_hi:[1,0,1]
v_pk_fma_f32 v[14:15], v[36:37], v[18:19], v[14:15] op_sel:[0,0,0] op_sel_hi:[1,0,1]
v_lshlrev_b32 v30, 16, v60
v_and_b32 v31, 0xffff0000, v60
v_lshlrev_b32 v32, 16, v61
v_and_b32 v33, 0xffff0000, v61
v_lshlrev_b32 v34, 16, v62
v_and_b32 v35, 0xffff0000, v62
v_lshlrev_b32 v36, 16, v63
v_and_b32 v37, 0xffff0000, v63
v_pk_fma_f32 v[8:9], v[30:31], v[20:21], v[8:9] op_sel:[0,0,0] op_sel_hi:[1,0,1]
v_pk_fma_f32 v[10:11], v[32:33], v[20:21], v[10:11] op_sel:[0,0,0] op_sel_hi:[1,0,1]
v_pk_fma_f32 v[12:13], v[34:35], v[20:21], v[12:13] op_sel:[0,0,0] op_sel_hi:[1,0,1]
v_pk_fma_f32 v[14:15], v[36:37], v[20:21], v[14:15] op_sel:[0,0,0] op_sel_hi:[1,0,1]
v_lshlrev_b32 v30, 16, v64
v_and_b32 v31, 0xffff0000, v64
v_lshlrev_b32 v32, 16, v65
v_and_b32 v33, 0xffff0000, v65
v_lshlrev_b32 v34, 16, v66
v_and_b32 v35, 0xffff0000, v66
v_lshlrev_b32 v36, 16, v67
v_and_b32 v37, 0xffff0000, v67
v_pk_fma_f32 v[8:9], v[30:31], v[22:23], v[8:9] op_sel:[0,0,0] op_sel_hi:[1,0,1]
v_pk_fma_f32 v[10:11], v[32:33], v[22:23], v[10:11] op_sel:[0,0,0] op_sel_hi:[1,0,1]
v_pk_fma_f32 v[12:13], v[34:35], v[22:23], v[12:13] op_sel:[0,0,0] op_sel_hi:[1,0,1]
v_pk_fma_f32 v[14:15], v[36:37], v[22:23], v[14:15] op_sel:[0,0,0] op_sel_hi:[1,0,1]
v_lshlrev_b32 v30, 16, v68
v_and_b32 v31, 0xffff0000, v68
v_lshlrev_b32 v32, 16, v69
v_and_b32 v33, 0xffff0000, v69
v_lshlrev_b32 v34, 16, v70
v_and_b32 v35, 0xffff0000, v70
v_lshlrev_b32 v36, 16, v71
v_and_b32 v37, 0xffff0000, v71
v_pk_fma_f32 v[8:9], v[30:31], v[24:25], v[8:9] op_sel:[0,0,0] op_sel_hi:[1,0,1]
v_pk_fma_f32 v[10:11], v[32:33], v[24:25], v[10:11] op_sel:[0,0,0] op_sel_hi:[1,0,1]
v_pk_fma_f32 v[12:13], v[34:35], v[24:25], v[12:13] op_sel:[0,0,0] op_sel_hi:[1,0,1]
v_pk_fma_f32 v[14:15], v[36:37], v[24:25], v[14:15] op_sel:[0,0,0] op_sel_hi:[1,0,1]
s_cmp_eq_u32 s39, s38
s_cbranch_scc1 L_sdone
s_add_u32 s39, s39, 1
s_cmp_eq_u32 s6, 2
s_cbranch_scc1 L_lds01
buffer_load_dwordx4 v[56:59], v1, s[44:47], 0 offen offset:0 nt
buffer_load_dwordx4 v[60:63], v1, s[44:47], 0 offen offset:1024 nt
buffer_load_dwordx4 v[64:67], v1, s[44:47], 0 offen offset:2048 nt
buffer_load_dwordx4 v[68:71], v1, s[44:47], 0 offen offset:3072 nt
v_add_u32 v1, 0x8000, v1
L_ldsdone01:
s_waitcnt vmcnt(28) lgkmcnt(0)
v_dot2_f32_bf16 v18, v72, v4, 0
v_dot2_f32_bf16 v20, v76, v4, 0
v_dot2_f32_bf16 v22, v80, v4, 0
v_dot2_f32_bf16 v24, v84, v4, 0
v_dot2_f32_bf16 v18, v73, v5, v18
v_dot2_f32_bf16 v20, v77, v5, v20
v_dot2_f32_bf16 v22, v81, v5, v22
v_dot2_f32_bf16 v24, v85, v5, v24
v_dot2_f32_bf16 v18, v74, v6, v18
v_dot2_f32_bf16 v20, v78, v6, v20
v_dot2_f32_bf16 v22, v82, v6, v22
v_dot2_f32_bf16 v24, v86, v6, v24
v_dot2_f32_bf16 v18, v75, v7, v18
v_dot2_f32_bf16 v20, v79, v7, v20
v_dot2_f32_bf16 v22, v83, v7, v22
v_dot2_f32_bf16 v24, v87, v7, v24
s_cmp_eq_u32 s6, 2
s_cbranch_scc1 L_lds10
buffer_load_dwordx4 v[72:75], v1, s[40:43], 0 offen offset:0 nt
buffer_load_dwordx4 v[76:79], v1, s[40:43], 0 offen offset:1024 nt
buffer_load_dwordx4 v[80:83], v1, s[40:43], 0 offen offset:2048 nt
buffer_load_dwordx4 v[84:87], v1, s[40:43], 0 offen offset:3072 nt
L_ldsdone10:
v_add_f32_dpp v18, v18, v18 quad_perm:[1,0,3,2] row_mask:0xf bank_mask:0xf
v_add_f32_dpp v20, v20, v20 quad_perm:[1,0,3,2] row_mask:0xf bank_mask:0xf
v_add_f32_dpp v22, v22, v22 quad_perm:[1,0,3,2] row_mask:0xf bank_mask:0xf
v_add_f32_dpp v24, v24, v24 quad_perm:[1,0,3,2] row_mask:0xf bank_mask:0xf
v_add_f32_dpp v18, v18, v18 quad_perm:[2,3,0,1] row_mask:0xf bank_mask:0xf
v_add_f32_dpp v20, v20, v20 quad_perm:[2,3,0,1] row_mask:0xf bank_mask:0xf
v_add_f32_dpp v22, v22, v22 quad_perm:[2,3,0,1] row_mask:0xf bank_mask:0xf
v_add_f32_dpp v24, v24, v24 quad_perm:[2,3,0,1] row_mask:0xf bank_mask:0xf
v_add_f32_dpp v18, v18, v18 row_half_mirror row_mask:0xf bank_mask:0xf
v_add_f32_dpp v20, v20, v20 row_half_mirror row_mask:0xf bank_mask:0xf
v_add_f32_dpp v22, v22, v22 row_half_mirror row_mask:0xf bank_mask:0xf
v_add_f32_dpp v24, v24, v24 row_half_mirror row_mask:0xf bank_mask:0xf
v_add_f32_dpp v18, v18, v18 row_mirror row_mask:0xf bank_mask:0xf
v_add_f32_dpp v20, v20, v20 row_mirror row_mask:0xf bank_mask:0xf
v_add_f32_dpp v22, v22, v22 row_mirror row_mask:0xf bank_mask:0xf
v_add_f32_dpp v24, v24, v24 row_mirror row_mask:0xf bank_mask:0xf
v_cvt_pk_bf16_f32 v26, v18, v20
v_cvt_pk_bf16_f32 v27, v22, v24
v_lshlrev_b32 v18, 16, v26
v_and_b32 v20, 0xffff0000, v26
v_lshlrev_b32 v22, 16, v27
v_and_b32 v24, 0xffff0000, v27
v_mul_f32 v18, s49, v18
v_mul_f32 v20, s49, v20
v_mul_f32 v22, s49, v22
v_mul_f32 v24, s49, v24
v_cvt_pk_bf16_f32 v26, v18, v20
v_cvt_pk_bf16_f32 v27, v22, v24
v_lshlrev_b32 v18, 16, v26
v_and_b32 v20, 0xffff0000, v26
v_lshlrev_b32 v22, 16, v27
v_and_b32 v24, 0xffff0000, v27
v_max3_f32 v26, v16, v18, v20
v_max3_f32 v26, v26, v22, v24
v_mul_f32 v27, s48, v26
v_fma_f32 v28, v16, s48, -v27
v_fma_f32 v18, v18, s48, -v27
v_fma_f32 v20, v20, s48, -v27
v_fma_f32 v22, v22, s48, -v27
v_fma_f32 v24, v24, s48, -v27
v_exp_f32 v28, v28
v_exp_f32 v18, v18
v_exp_f32 v20, v20
v_exp_f32 v22, v22
v_exp_f32 v24, v24
v_mov_b32 v16, v26
v_pk_mul_f32 v[8:9], v[8:9], v[28:29] op_sel:[0,0] op_sel_hi:[1,0]
v_pk_mul_f32 v[10:11], v[10:11], v[28:29] op_sel:[0,0] op_sel_hi:[1,0]
v_pk_mul_f32 v[12:13], v[12:13], v[28:29] op_sel:[0,0] op_sel_hi:[1,0]
v_pk_mul_f32 v[14:15], v[14:15], v[28:29] op_sel:[0,0] op_sel_hi:[1,0]
v_fma_f32 v17, v17, v28, v18
v_add_f32 v26, v20, v22
v_add_f32 v17, v17, v24
v_add_f32 v17, v17, v26
s_waitcnt vmcnt(28)
v_lshlrev_b32 v30, 16, v88
v_and_b32 v31, 0xffff0000, v88
v_lshlrev_b32 v32, 16, v89
v_and_b32 v33, 0xffff0000, v89
v_lshlrev_b32 v34, 16, v90
v_and_b32 v35, 0xffff0000, v90
v_lshlrev_b32 v36, 16, v91
v_and_b32 v37, 0xffff0000, v91
v_pk_fma_f32 v[8:9], v[30:31], v[18:19], v[8:9] op_sel:[0,0,0] op_sel_hi:[1,0,1]
v_pk_fma_f32 v[10:11], v[32:33], v[18:19], v[10:11] op_sel:[0,0,0] op_sel_hi:[1,0,1]
v_pk_fma_f32 v[12:13], v[34:35], v[18:19], v[12:13] op_sel:[0,0,0] op_sel_hi:[1,0,1]
v_pk_fma_f32 v[14:15], v[36:37], v[18:19], v[14:15] op_sel:[0,0,0] op_sel_hi:[1,0,1]
v_lshlrev_b32 v30, 16, v92
v_and_b32 v31, 0xffff0000, v92
v_lshlrev_b32 v32, 16, v93
v_and_b32 v33, 0xffff0000, v93
v_lshlrev_b32 v34, 16, v94
v_and_b32 v35, 0xffff0000, v94
v_lshlrev_b32 v36, 16, v95
v_and_b32 v37, 0xffff0000, v95
v_pk_fma_f32 v[8:9], v[30:31], v[20:21], v[8:9] op_sel:[0,0,0] op_sel_hi:[1,0,1]
v_pk_fma_f32 v[10:11], v[32:33], v[20:21], v[10:11] op_sel:[0,0,0] op_sel_hi:[1,0,1]
v_pk_fma_f32 v[12:13], v[34:35], v[20:21], v[12:13] op_sel:[0,0,0] op_sel_hi:[1,0,1]
v_pk_fma_f32 v[14:15], v[36:37], v[20:21], v[14:15] op_sel:[0,0,0] op_sel_hi:[1,0,1]
v_lshlrev_b32 v30, 16, v96
v_and_b32 v31, 0xffff0000, v96
v_lshlrev_b32 v32, 16, v97
v_and_b32 v33, 0xffff0000, v97
v_lshlrev_b32 v34, 16, v98
v_and_b32 v35, 0xffff0000, v98
v_lshlrev_b32 v36, 16, v99
v_and_b32 v37, 0xffff0000, v99
v_pk_fma_f32 v[8:9], v[30:31], v[22:23], v[8:9] op_sel:[0,0,0] op_sel_hi:[1,0,1]
v_pk_fma_f32 v[10:11], v[32:33], v[22:23], v[10:11] op_sel:[0,0,0] op_sel_hi:[1,0,1]
v_pk_fma_f32 v[12:13], v[34:35], v[22:23], v[12:13] op_sel:[0,0,0] op_sel_hi:[1,0,1]
v_pk_fma_f32 v[14:15], v[36:37], v[22:23], v[14:15] op_sel:[0,0,0] op_sel_hi:[1,0,1]
v_lshlrev_b32 v30, 16, v100
v_and_b32 v31, 0xffff0000, v100
v_lshlrev_b32 v32, 16, v101
v_and_b32 v33, 0xffff0000, v101
v_lshlrev_b32 v34, 16, v102
v_and_b32 v35, 0xffff0000, v102
v_lshlrev_b32 v36, 16, v103
v_and_b32 v37, 0xffff0000, v103
v_pk_fma_f32 v[8:9], v[30:31], v[24:25], v[8:9] op_sel:[0,0,0] op_sel_hi:[1,0,1]
v_pk_fma_f32 v[10:11], v[32:33], v[24:25], v[10:11] op_sel:[0,0,0] op_sel_hi:[1,0,1]
v_pk_fma_f32 v[12:13], v[34:35], v[24:25], v[12:13] op_sel:[0,0,0] op_sel_hi:[1,0,1]
v_pk_fma_f32 v[14:15], v[36:37], v[24:25], v[14:15] op_sel:[0,0,0] op_sel_hi:[1,0,1]
s_cmp_eq_u32 s39, s38
s_cbranch_scc1 L_sdone
s_add_u32 s39, s39, 1
s_cmp_eq_u32 s6, 2
s_cbranch_scc1 L_lds11
buffer_load_dwordx4 v[88:91], v1, s[44:47], 0 offen offset:0 nt
buffer_load_dwordx4 v[92:95], v1, s[44:47], 0 offen offset:1024 nt
buffer_load_dwordx4 v[96:99], v1, s[44:47], 0 offen offset:2048 nt
buffer_load_dwordx4 v[100:103], v1, s[44:47], 0 offen offset:3072 nt
v_add_u32 v1, 0x8000, v1
L_ldsdone11:
s_waitcnt vmcnt(28)
v_dot2_f32_bf16 v18, v104, v4, 0
v_dot2_f32_bf16 v20, v108, v4, 0
v_dot2_f32_bf16 v22, v112, v4, 0
v_dot2_f32_bf16 v24, v116, v4, 0
v_dot2_f32_bf16 v18, v105, v5, v18
v_dot2_f32_bf16 v20, v109, v5, v20
v_dot2_f32_bf16 v22, v113, v5, v22
v_dot2_f32_bf16 v24, v117, v5, v24
v_dot2_f32_bf16 v18, v106, v6, v18
v_dot2_f32_bf16 v20, v110, v6, v20
v_dot2_f32_bf16 v22, v114, v6, v22
v_dot2_f32_bf16 v24, v118, v6, v24
v_dot2_f32_bf16 v18, v107, v7, v18
v_dot2_f32_bf16 v20, v111, v7, v20
v_dot2_f32_bf16 v22, v115, v7, v22
v_dot2_f32_bf16 v24, v119, v7, v24
buffer_load_dwordx4 v[104:107], v1, s[40:43], 0 offen offset:0 nt
buffer_load_dwordx4 v[108:111], v1, s[40:43], 0 offen offset:1024 nt
buffer_load_dwordx4 v[112:115], v1, s[40:43], 0 offen offset:2048 nt
buffer_load_dwordx4 v[116:119], v1, s[40:43], 0 offen offset:3072 nt
v_add_f32_dpp v18, v18, v18 quad_perm:[1,0,3,2] row_mask:0xf bank_mask:0xf
v_add_f32_dpp v20, v20, v20 quad_perm:[1,0,3,2] row_mask:0xf bank_mask:0xf
v_add_f32_dpp v22, v22, v22 quad_perm:[1,0,3,2] row_mask:0xf bank_mask:0xf
v_add_f32_dpp v24, v24, v24 quad_perm:[1,0,3,2] row_mask:0xf bank_mask:0xf
v_add_f32_dpp v18, v18, v18 quad_perm:[2,3,0,1] row_mask:0xf bank_mask:0xf
v_add_f32_dpp v20, v20, v20 quad_perm:[2,3,0,1] row_mask:0xf bank_mask:0xf
v_add_f32_dpp v22, v22, v22 quad_perm:[2,3,0,1] row_mask:0xf bank_mask:0xf
v_add_f32_dpp v24, v24, v24 quad_perm:[2,3,0,1] row_mask:0xf bank_mask:0xf
v_add_f32_dpp v18, v18, v18 row_half_mirror row_mask:0xf bank_mask:0xf
v_add_f32_dpp v20, v20, v20 row_half_mirror row_mask:0xf bank_mask:0xf
v_add_f32_dpp v22, v22, v22 row_half_mirror row_mask:0xf bank_mask:0xf
v_add_f32_dpp v24, v24, v24 row_half_mirror row_mask:0xf bank_mask:0xf
v_add_f32_dpp v18, v18, v18 row_mirror row_mask:0xf bank_mask:0xf
v_add_f32_dpp v20, v20, v20 row_mirror row_mask:0xf bank_mask:0xf
v_add_f32_dpp v22, v22, v22 row_mirror row_mask:0xf bank_mask:0xf
v_add_f32_dpp v24, v24, v24 row_mirror row_mask:0xf bank_mask:0xf
v_cvt_pk_bf16_f32 v26, v18, v20
v_cvt_pk_bf16_f32 v27, v22, v24
v_lshlrev_b32 v18, 16, v26
v_and_b32 v20, 0xffff0000, v26
v_lshlrev_b32 v22, 16, v27
v_and_b32 v24, 0xffff0000, v27
v_mul_f32 v18, s49, v18
v_mul_f32 v20, s49, v20
v_mul_f32 v22, s49, v22
v_mul_f32 v24, s49, v24
v_cvt_pk_bf16_f32 v26, v18, v20
v_cvt_pk_bf16_f32 v27, v22, v24
v_lshlrev_b32 v18, 16, v26
v_and_b32 v20, 0xffff0000, v26
v_lshlrev_b32 v22, 16, v27
v_and_b32 v24, 0xffff0000, v27
v_max3_f32 v26, v16, v18, v20
v_max3_f32 v26, v26, v22, v24
v_mul_f32 v27, s48, v26
v_fma_f32 v28, v16, s48, -v27
v_fma_f32 v18, v18, s48, -v27
v_fma_f32 v20, v20, s48, -v27
v_fma_f32 v22, v22, s48, -v27
v_fma_f32 v24, v24, s48, -v27
v_exp_f32 v28, v28
v_exp_f32 v18, v18
v_exp_f32 v20, v20
v_exp_f32 v22, v22
v_exp_f32 v24, v24
v_mov_b32 v16, v26
v_pk_mul_f32 v[8:9], v[8:9], v[28:29] op_sel:[0,0] op_sel_hi:[1,0]
v_pk_mul_f32 v[10:11], v[10:11], v[28:29] op_sel:[0,0] op_sel_hi:[1,0]
v_pk_mul_f32 v[12:13], v[12:13], v[28:29] op_sel:[0,0] op_sel_hi:[1,0]
v_pk_mul_f32 v[14:15], v[14:15], v[28:29] op_sel:[0,0] op_sel_hi:[1,0]
v_fma_f32 v17, v17, v28, v18
v_add_f32 v26, v20, v22
v_add_f32 v17, v17, v24
v_add_f32 v17, v17, v26
s_waitcnt vmcnt(28)
v_lshlrev_b32 v30, 16, v120
v_and_b32 v31, 0xffff0000, v120
v_lshlrev_b32 v32, 16, v121
v_and_b32 v33, 0xffff0000, v121
v_lshlrev_b32 v34, 16, v122
v_and_b32 v35, 0xffff0000, v122
v_lshlrev_b32 v36, 16, v123
v_and_b32 v37, 0xffff0000, v123
v_pk_fma_f32 v[8:9], v[30:31], v[18:19], v[8:9] op_sel:[0,0,0] op_sel_hi:[1,0,1]
v_pk_fma_f32 v[10:11], v[32:33], v[18:19], v[10:11] op_sel:[0,0,0] op_sel_hi:[1,0,1]
v_pk_fma_f32 v[12:13], v[34:35], v[18:19], v[12:13] op_sel:[0,0,0] op_sel_hi:[1,0,1]
v_pk_fma_f32 v[14:15], v[36:37], v[18:19], v[14:15] op_sel:[0,0,0] op_sel_hi:[1,0,1]
v_lshlrev_b32 v30, 16, v124
v_and_b32 v31, 0xffff0000, v124
v_lshlrev_b32 v32, 16, v125
v_and_b32 v33, 0xffff0000, v125
v_lshlrev_b32 v34, 16, v126
v_and_b32 v35, 0xffff0000, v126
v_lshlrev_b32 v36, 16, v127
v_and_b32 v37, 0xffff0000, v127
v_pk_fma_f32 v[8:9], v[30:31], v[20:21], v[8:9] op_sel:[0,0,0] op_sel_hi:[1,0,1]
v_pk_fma_f32 v[10:11], v[32:33], v[20:21], v[10:11] op_sel:[0,0,0] op_sel_hi:[1,0,1]
v_pk_fma_f32 v[12:13], v[34:35], v[20:21], v[12:13] op_sel:[0,0,0] op_sel_hi:[1,0,1]
v_pk_fma_f32 v[14:15], v[36:37], v[20:21], v[14:15] op_sel:[0,0,0] op_sel_hi:[1,0,1]
v_lshlrev_b32 v30, 16, v128
v_and_b32 v31, 0xffff0000, v128
v_lshlrev_b32 v32, 16, v129
v_and_b32 v33, 0xffff0000, v129
v_lshlrev_b32 v34, 16, v130
v_and_b32 v35, 0xffff0000, v130
v_lshlrev_b32 v36, 16, v131
v_and_b32 v37, 0xffff0000, v131
v_pk_fma_f32 v[8:9], v[30:31], v[22:23], v[8:9] op_sel:[0,0,0] op_sel_hi:[1,0,1]
v_pk_fma_f32 v[10:11], v[32:33], v[22:23], v[10:11] op_sel:[0,0,0] op_sel_hi:[1,0,1]
v_pk_fma_f32 v[12:13], v[34:35], v[22:23], v[12:13] op_sel:[0,0,0] op_sel_hi:[1,0,1]
v_pk_fma_f32 v[14:15], v[36:37], v[22:23], v[14:15] op_sel:[0,0,0] op_sel_hi:[1,0,1]
v_lshlrev_b32 v30, 16, v132
v_and_b32 v31, 0xffff0000, v132
v_lshlrev_b32 v32, 16, v133
v_and_b32 v33, 0xffff0000, v133
v_lshlrev_b32 v34, 16, v134
v_and_b32 v35, 0xffff0000, v134
v_lshlrev_b32 v36, 16, v135
v_and_b32 v37, 0xffff0000, v135
v_pk_fma_f32 v[8:9], v[30:31], v[24:25], v[8:9] op_sel:[0,0,0] op_sel_hi:[1,0,1]
v_pk_fma_f32 v[10:11], v[32:33], v[24:25], v[10:11] op_sel:[0,0,0] op_sel_hi:[1,0,1]
v_pk_fma_f32 v[12:13], v[34:35], v[24:25], v[12:13] op_sel:[0,0,0] op_sel_hi:[1,0,1]
v_pk_fma_f32 v[14:15], v[36:37], v[24:25], v[14:15] op_sel:[0,0,0] op_sel_hi:[1,0,1]
s_cmp_eq_u32 s39, s38
s_cbranch_scc1 L_sdone
s_add_u32 s39, s39, 1
buffer_load_dwordx4 v[120:123], v1, s[44:47], 0 offen offset:0 nt
buffer_load_dwordx4 v[124:127], v1, s[44:47], 0 offen offset:1024 nt
buffer_load_dwordx4 v[128:131], v1, s[44:47], 0 offen offset:2048 nt
buffer_load_dwordx4 v[132:135], v1, s[44:47], 0 offen offset:3072 nt
v_add_u32 v1, 0x8000, v1
s_waitcnt vmcnt(28)
v_dot2_f32_bf16 v18, v136, v4, 0
v_dot2_f32_bf16 v20, v140, v4, 0
v_dot2_f32_bf16 v22, v144, v4, 0
v_dot2_f32_bf16 v24, v148, v4, 0
v_dot2_f32_bf16 v18, v137, v5, v18
v_dot2_f32_bf16 v20, v141, v5, v20
v_dot2_f32_bf16 v22, v145, v5, v22
v_dot2_f32_bf16 v24, v149, v5, v24
v_dot2_f32_bf16 v18, v138, v6, v18
v_dot2_f32_bf16 v20, v142, v6, v20
v_dot2_f32_bf16 v22, v146, v6, v22
v_dot2_f32_bf16 v24, v150, v6, v24
v_dot2_f32_bf16 v18, v139, v7, v18
v_dot2_f32_bf16 v20, v143, v7, v20
v_dot2_f32_bf16 v22, v147, v7, v22
v_dot2_f32_bf16 v24, v151, v7, v24
buffer_load_dwordx4 v[136:139], v1, s[40:43], 0 offen offset:0 nt
buffer_load_dwordx4 v[140:143], v1, s[40:43], 0 offen offset:1024 nt
buffer_load_dwordx4 v[144:147], v1, s[40:43], 0 offen offset:2048 nt
buffer_load_dwordx4 v[148:151], v1, s[40:43], 0 offen offset:3072 nt
v_add_f32_dpp v18, v18, v18 quad_perm:[1,0,3,2] row_mask:0xf bank_mask:0xf
v_add_f32_dpp v20, v20, v20 quad_perm:[1,0,3,2] row_mask:0xf bank_mask:0xf
v_add_f32_dpp v22, v22, v22 quad_perm:[1,0,3,2] row_mask:0xf bank_mask:0xf
v_add_f32_dpp v24, v24, v24 quad_perm:[1,0,3,2] row_mask:0xf bank_mask:0xf
v_add_f32_dpp v18, v18, v18 quad_perm:[2,3,0,1] row_mask:0xf bank_mask:0xf
v_add_f32_dpp v20, v20, v20 quad_perm:[2,3,0,1] row_mask:0xf bank_mask:0xf
v_add_f32_dpp v22, v22, v22 quad_perm:[2,3,0,1] row_mask:0xf bank_mask:0xf
v_add_f32_dpp v24, v24, v24 quad_perm:[2,3,0,1] row_mask:0xf bank_mask:0xf
v_add_f32_dpp v18, v18, v18 row_half_mirror row_mask:0xf bank_mask:0xf
v_add_f32_dpp v20, v20, v20 row_half_mirror row_mask:0xf bank_mask:0xf
v_add_f32_dpp v22, v22, v22 row_half_mirror row_mask:0xf bank_mask:0xf
v_add_f32_dpp v24, v24, v24 row_half_mirror row_mask:0xf bank_mask:0xf
v_add_f32_dpp v18, v18, v18 row_mirror row_mask:0xf bank_mask:0xf
v_add_f32_dpp v20, v20, v20 row_mirror row_mask:0xf bank_mask:0xf
v_add_f32_dpp v22, v22, v22 row_mirror row_mask:0xf bank_mask:0xf
v_add_f32_dpp v24, v24, v24 row_mirror row_mask:0xf bank_mask:0xf
v_cvt_pk_bf16_f32 v26, v18, v20
v_cvt_pk_bf16_f32 v27, v22, v24
v_lshlrev_b32 v18, 16, v26
v_and_b32 v20, 0xffff0000, v26
v_lshlrev_b32 v22, 16, v27
v_and_b32 v24, 0xffff0000, v27
v_mul_f32 v18, s49, v18
v_mul_f32 v20, s49, v20
v_mul_f32 v22, s49, v22
v_mul_f32 v24, s49, v24
v_cvt_pk_bf16_f32 v26, v18, v20
v_cvt_pk_bf16_f32 v27, v22, v24
v_lshlrev_b32 v18, 16, v26
v_and_b32 v20, 0xffff0000, v26
v_lshlrev_b32 v22, 16, v27
v_and_b32 v24, 0xffff0000, v27
v_max3_f32 v26, v16, v18, v20
v_max3_f32 v26, v26, v22, v24
v_mul_f32 v27, s48, v26
v_fma_f32 v28, v16, s48, -v27
v_fma_f32 v18, v18, s48, -v27
v_fma_f32 v20, v20, s48, -v27
v_fma_f32 v22, v22, s48, -v27
v_fma_f32 v24, v24, s48, -v27
v_exp_f32 v28, v28
v_exp_f32 v18, v18
v_exp_f32 v20, v20
v_exp_f32 v22, v22
v_exp_f32 v24, v24
v_mov_b32 v16, v26
v_pk_mul_f32 v[8:9], v[8:9], v[28:29] op_sel:[0,0] op_sel_hi:[1,0]
v_pk_mul_f32 v[10:11], v[10:11], v[28:29] op_sel:[0,0] op_sel_hi:[1,0]
v_pk_mul_f32 v[12:13], v[12:13], v[28:29] op_sel:[0,0] op_sel_hi:[1,0]
v_pk_mul_f32 v[14:15], v[14:15], v[28:29] op_sel:[0,0] op_sel_hi:[1,0]
v_fma_f32 v17, v17, v28, v18
v_add_f32 v26, v20, v22
v_add_f32 v17, v17, v24
v_add_f32 v17, v17, v26
s_waitcnt vmcnt(28)
v_lshlrev_b32 v30, 16, v152
v_and_b32 v31, 0xffff0000, v152
v_lshlrev_b32 v32, 16, v153
v_and_b32 v33, 0xffff0000, v153
v_lshlrev_b32 v34, 16, v154
v_and_b32 v35, 0xffff0000, v154
v_lshlrev_b32 v36, 16, v155
v_and_b32 v37, 0xffff0000, v155
v_pk_fma_f32 v[8:9], v[30:31], v[18:19], v[8:9] op_sel:[0,0,0] op_sel_hi:[1,0,1]
v_pk_fma_f32 v[10:11], v[32:33], v[18:19], v[10:11] op_sel:[0,0,0] op_sel_hi:[1,0,1]
v_pk_fma_f32 v[12:13], v[34:35], v[18:19], v[12:13] op_sel:[0,0,0] op_sel_hi:[1,0,1]
v_pk_fma_f32 v[14:15], v[36:37], v[18:19], v[14:15] op_sel:[0,0,0] op_sel_hi:[1,0,1]
v_lshlrev_b32 v30, 16, v156
v_and_b32 v31, 0xffff0000, v156
v_lshlrev_b32 v32, 16, v157
v_and_b32 v33, 0xffff0000, v157
v_lshlrev_b32 v34, 16, v158
v_and_b32 v35, 0xffff0000, v158
v_lshlrev_b32 v36, 16, v159
v_and_b32 v37, 0xffff0000, v159
v_pk_fma_f32 v[8:9], v[30:31], v[20:21], v[8:9] op_sel:[0,0,0] op_sel_hi:[1,0,1]
v_pk_fma_f32 v[10:11], v[32:33], v[20:21], v[10:11] op_sel:[0,0,0] op_sel_hi:[1,0,1]
v_pk_fma_f32 v[12:13], v[34:35], v[20:21], v[12:13] op_sel:[0,0,0] op_sel_hi:[1,0,1]
v_pk_fma_f32 v[14:15], v[36:37], v[20:21], v[14:15] op_sel:[0,0,0] op_sel_hi:[1,0,1]
v_lshlrev_b32 v30, 16, v160
v_and_b32 v31, 0xffff0000, v160
v_lshlrev_b32 v32, 16, v161
v_and_b32 v33, 0xffff0000, v161
v_lshlrev_b32 v34, 16, v162
v_and_b32 v35, 0xffff0000, v162
v_lshlrev_b32 v36, 16, v163
v_and_b32 v37, 0xffff0000, v163
v_pk_fma_f32 v[8:9], v[30:31], v[22:23], v[8:9] op_sel:[0,0,0] op_sel_hi:[1,0,1]
v_pk_fma_f32 v[10:11], v[32:33], v[22:23], v[10:11] op_sel:[0,0,0] op_sel_hi:[1,0,1]
v_pk_fma_f32 v[12:13], v[34:35], v[22:23], v[12:13] op_sel:[0,0,0] op_sel_hi:[1,0,1]
v_pk_fma_f32 v[14:15], v[36:37], v[22:23], v[14:15] op_sel:[0,0,0] op_sel_hi:[1,0,1]
v_lshlrev_b32 v30, 16, v164
v_and_b32 v31, 0xffff0000, v164
v_lshlrev_b32 v32, 16, v165
v_and_b32 v33, 0xffff0000, v165
v_lshlrev_b32 v34, 16, v166
v_and_b32 v35, 0xffff0000, v166
v_lshlrev_b32 v36, 16, v167
v_and_b32 v37, 0xffff0000, v167
v_pk_fma_f32 v[8:9], v[30:31], v[24:25], v[8:9] op_sel:[0,0,0] op_sel_hi:[1,0,1]
v_pk_fma_f32 v[10:11], v[32:33], v[24:25], v[10:11] op_sel:[0,0,0] op_sel_hi:[1,0,1]
v_pk_fma_f32 v[12:13], v[34:35], v[24:25], v[12:13] op_sel:[0,0,0] op_sel_hi:[1,0,1]
v_pk_fma_f32 v[14:15], v[36:37], v[24:25], v[14:15] op_sel:[0,0,0] op_sel_hi:[1,0,1]
s_cmp_eq_u32 s39, s38
s_cbranch_scc1 L_sdone
s_add_u32 s39, s39, 1
buffer_load_dwordx4 v[152:155], v1, s[44:47], 0 offen offset:0 nt
buffer_load_dwordx4 v[156:159], v1, s[44:47], 0 offen offset:1024 nt
buffer_load_dwordx4 v[160:163], v1, s[44:47], 0 offen offset:2048 nt
buffer_load_dwordx4 v[164:167], v1, s[44:47], 0 offen offset:3072 nt
v_add_u32 v1, 0x8000, v1
s_add_u32 s6, s6, 1
s_cmp_eq_u32 s6, 1
s_cbranch_scc1 L_sfirst
s_cmp_lg_u32 s6, 3
s_cbranch_scc1 L_sloop
v_mov_b32 v26, 0
v_mov_b32 v27, 1
ds_write_b32 v26, v27 offset:8260
s_branch L_sloop
L_lds00:
ds_read_b128 v[40:43], v19 offset:0
ds_read_b128 v[44:47], v19 offset:1024
ds_read_b128 v[48:51], v19 offset:2048
ds_read_b128 v[52:55], v19 offset:3072
s_mov_b32 m0, 12288
s_nop 0
buffer_load_dwordx4 v39, s[40:43], 0 offen offset:0 lds
buffer_load_dwordx4 v39, s[40:43], 0 offen offset:1024 lds
buffer_load_dwordx4 v39, s[40:43], 0 offen offset:2048 lds
buffer_load_dwordx4 v39, s[40:43], 0 offen offset:3072 lds
s_branch L_ldsdone00
L_lds01:
ds_read_b128 v[56:59], v19 offset:4096
ds_read_b128 v[60:63], v19 offset:5120
ds_read_b128 v[64:67], v19 offset:6144
ds_read_b128 v[68:71], v19 offset:7168
s_mov_b32 m0, 12288
s_nop 0
buffer_load_dwordx4 v39, s[44:47], 0 offen offset:0 lds
buffer_load_dwordx4 v39, s[44:47], 0 offen offset:1024 lds
buffer_load_dwordx4 v39, s[44:47], 0 offen offset:2048 lds
buffer_load_dwordx4 v39, s[44:47], 0 offen offset:3072 lds
s_branch L_ldsdone01
L_lds10:
ds_read_b128 v[72:75], v19 offset:8192
ds_read_b128 v[76:79], v19 offset:9216
ds_read_b128 v[80:83], v19 offset:10240
ds_read_b128 v[84:87], v19 offset:11264
s_mov_b32 m0, 12288
s_nop 0
buffer_load_dwordx4 v39, s[40:43], 0 offen offset:0 lds
buffer_load_dwordx4 v39, s[40:43], 0 offen offset:1024 lds
buffer_load_dwordx4 v39, s[40:43], 0 offen offset:2048 lds
buffer_load_dwordx4 v39, s[40:43], 0 offen offset:3072 lds
s_branch L_ldsdone10
L_lds11:
ds_read_b128 v[88:91], v19 offset:12288
ds_read_b128 v[92:95], v19 offset:13312
ds_read_b128 v[96:99], v19 offset:14336
ds_read_b128 v[100:103], v19 offset:15360
s_mov_b32 m0, 12288
s_nop 0
buffer_load_dwordx4 v39, s[44:47], 0 offen offset:0 lds
buffer_load_dwordx4 v39, s[44:47], 0 offen offset:1024 lds
buffer_load_dwordx4 v39, s[44:47], 0 offen offset:2048 lds
buffer_load_dwordx4 v39, s[44:47], 0 offen offset:3072 lds
s_branch L_ldsdone11
L_sfirst:
s_add_u32 m0, s50, 8192
s_nop 0
buffer_load_dwordx4 v38, s[40:43], 0 offen offset:0 nt lds
buffer_load_dwordx4 v38, s[40:43], 0 offen offset:1024 nt lds
buffer_load_dwordx4 v38, s[40:43], 0 offen offset:2048 nt lds
buffer_load_dwordx4 v38, s[40:43], 0 offen offset:3072 nt lds
s_add_u32 m0, s50, 12288
s_nop 0
buffer_load_dwordx4 v38, s[44:47], 0 offen offset:0 nt lds
buffer_load_dwordx4 v38, s[44:47], 0 offen offset:1024 nt lds
buffer_load_dwordx4 v38, s[44:47], 0 offen offset:2048 nt lds
buffer_load_dwordx4 v38, s[44:47], 0 offen offset:3072 nt lds
v_add_u32 v38, 0x8000, v38
s_barrier
ds_read_b128 v[4:7], v3 offset:8320
v_mov_b32 v8, 0
v_mov_b32 v9, 0
v_mov_b32 v10, 0
v_mov_b32 v11, 0
v_mov_b32 v12, 0
v_mov_b32 v13, 0
v_mov_b32 v14, 0
v_mov_b32 v15, 0
v_mov_b32 v16, 0xff7fffff
v_mov_b32 v17, 0
s_waitcnt lgkmcnt(0)
s_add_u32 s52, s52, 1
s_addc_u32 s53, s53, 0
s_branch L_sloop
L_sdone:
v_mov_b32 v26, v16
v_mov_b32 v27, v26
s_nop 1
v_permlane16_swap_b32 v26, v27
v_max_f32 v26, v26, v27
v_mov_b32 v27, v26
s_nop 1
v_permlane32_swap_b32 v26, v27
v_max_f32 v26, v26, v27
v_sub_f32 v28, v16, v26
v_mul_f32 v28, s48, v28
v_exp_f32 v28, v28
v_lshrrev_b32 v30, 4, v2
v_lshlrev_b32 v30, 2, v30
v_lshl_add_u32 v30, v3, 1, v30
s_lshl_b32 s7, s3, 9
v_add_u32 v30, s7, v30
s_lshl_b32 s7, s3, 3
v_mov_b32 v31, s7
v_pk_mul_f32 v[8:9], v[8:9], v[28:29] op_sel:[0,0] op_sel_hi:[1,0]
v_pk_mul_f32 v[10:11], v[10:11], v[28:29] op_sel:[0,0] op_sel_hi:[1,0]
v_pk_mul_f32 v[12:13], v[12:13], v[28:29] op_sel:[0,0] op_sel_hi:[1,0]
v_pk_mul_f32 v[14:15], v[14:15], v[28:29] op_sel:[0,0] op_sel_hi:[1,0]
v_mul_f32 v27, v17, v28
v_mov_b32 v29, v27
v_permlane16_swap_b32 v8, v9
v_permlane16_swap_b32 v10, v11
v_permlane16_swap_b32 v12, v13
v_permlane16_swap_b32 v14, v15
v_permlane16_swap_b32 v27, v29
v_add_f32 v8, v8, v9
v_add_f32 v10, v10, v11
v_add_f32 v12, v12, v13
v_add_f32 v14, v14, v15
v_add_f32 v27, v27, v29
v_mov_b32 v29, v27
v_permlane32_swap_b32 v8, v10
v_permlane32_swap_b32 v12, v14
v_permlane32_swap_b32 v27, v29
v_add_f32 v8, v8, v10
v_add_f32 v12, v12, v14
v_add_f32 v27, v27, v29
ds_write_b32 v30, v8 offset:4096
ds_write_b32 v30, v12 offset:4112
ds_write_b64 v31, v[26:27] offset:8192
v_mov_b32 v32, 0
v_mov_b32 v33, 1
s_waitcnt vmcnt(0) lgkmcnt(0)
s_mov_b64 exec, 1
ds_add_rtn_u32 v34, v32, v33 offset:8264
s_mov_b64 exec, -1
v_lshlrev_b32 v4, 3, v2
s_lshl_b32 s7, s5, 3
s_add_u32 s7, s7, s4
s_lshl_b32 s46, s7, 10
s_add_u32 s46, s46, 524288
v_lshl_add_u32 v6, v2, 4, s46
s_lshl_b32 s46, s7, 4
s_add_u32 s46, s46, 163840
v_mov_b32 v5, s46
s_waitcnt lgkmcnt(0)
v_readfirstlane_b32 s7, v34
s_nop 0
s_cmp_lg_u32 s7, 7
s_cbranch_scc1 L_done
ds_read_b128 v[100:103], v32 offset:8192
ds_read_b128 v[104:107], v32 offset:8208
ds_read_b128 v[108:111], v32 offset:8224
ds_read_b128 v[112:115], v32 offset:8240
ds_read_b64 v[132:133], v4 offset:4096
ds_read_b64 v[134:135], v4 offset:4608
ds_read_b64 v[136:137], v4 offset:5120
ds_read_b64 v[138:139], v4 offset:5632
ds_read_b64 v[140:141], v4 offset:6144
ds_read_b64 v[142:143], v4 offset:6656
ds_read_b64 v[144:145], v4 offset:7168
ds_read_b64 v[146:147], v4 offset:7680
v_mov_b32 v22, s52
v_mov_b32 v23, s53
s_waitcnt lgkmcnt(8)
v_max3_f32 v26, v100, v102, v104
v_max3_f32 v27, v106, v108, v110
v_max3_f32 v26, v26, v112, v114
v_max_f32 v20, v26, v27
v_mul_f32 v28, s48, v20
v_fma_f32 v100, v100, s48, -v28
v_fma_f32 v102, v102, s48, -v28
v_fma_f32 v104, v104, s48, -v28
v_fma_f32 v106, v106, s48, -v28
v_fma_f32 v108, v108, s48, -v28
v_fma_f32 v110, v110, s48, -v28
v_fma_f32 v112, v112, s48, -v28
v_fma_f32 v114, v114, s48, -v28
v_exp_f32 v100, v100
v_exp_f32 v102, v102
v_exp_f32 v104, v104
v_exp_f32 v106, v106
v_exp_f32 v108, v108
v_exp_f32 v110, v110
v_exp_f32 v112, v112
v_exp_f32 v114, v114
s_waitcnt lgkmcnt(0)
v_mul_f32 v21, v100, v101
v_mul_f32 v29, v102, v103
v_pk_mul_f32 v[24:25], v[132:133], v[100:101] op_sel:[0,0] op_sel_hi:[1,0]
v_pk_mul_f32 v[30:31], v[134:135], v[102:103] op_sel:[0,0] op_sel_hi:[1,0]
v_fmac_f32 v21, v104, v105
v_pk_fma_f32 v[24:25], v[136:137], v[104:105], v[24:25] op_sel:[0,0,0] op_sel_hi:[1,0,1]
v_fmac_f32 v29, v106, v107
v_pk_fma_f32 v[30:31], v[138:139], v[106:107], v[30:31] op_sel:[0,0,0] op_sel_hi:[1,0,1]
v_fmac_f32 v21, v108, v109
v_pk_fma_f32 v[24:25], v[140:141], v[108:109], v[24:25] op_sel:[0,0,0] op_sel_hi:[1,0,1]
v_fmac_f32 v29, v110, v111
v_pk_fma_f32 v[30:31], v[142:143], v[110:111], v[30:31] op_sel:[0,0,0] op_sel_hi:[1,0,1]
v_fmac_f32 v21, v112, v113
v_pk_fma_f32 v[24:25], v[144:145], v[112:113], v[24:25] op_sel:[0,0,0] op_sel_hi:[1,0,1]
v_fmac_f32 v29, v114, v115
v_pk_fma_f32 v[30:31], v[146:147], v[114:115], v[30:31] op_sel:[0,0,0] op_sel_hi:[1,0,1]
v_add_f32 v21, v21, v29
v_pk_add_f32 v[24:25], v[24:25], v[30:31] op_sel:[0,0] op_sel_hi:[1,1]
v_mov_b32 v26, s52
v_mov_b32 v27, s53
global_store_dwordx4 v6, v[24:27], s[36:37] sc1
s_mov_b64 exec, 1
global_store_dwordx4 v5, v[20:23], s[36:37] sc1
L_done:
s_endpgm
.section .rodata,"a"
.p2align 6
.amdhsa_kernel adaLN_cond__mha_block_cached__mixer_token_mlp__decode_kernel
.amdhsa_next_free_vgpr 168
.amdhsa_next_free_sgpr 96
.amdhsa_accum_offset 168
.amdhsa_group_segment_fixed_size 0
.amdhsa_kernarg_size 120
.amdhsa_user_sgpr_count 2
.amdhsa_user_sgpr_kernarg_segment_ptr 1
.amdhsa_system_sgpr_workgroup_id_x 1
.amdhsa_float_denorm_mode_32 3
.end_amdhsa_kernel
```
